```python
import torch

def _softmax(x, axis=-1):
    return torch.softmax(x, dim=axis)
def _gelu(x):
    return torch.nn.functional.gelu(x, approximate="tanh")
def _silu(x):
    return torch.nn.functional.silu(x)
def _sigmoid(x):
    return torch.sigmoid(x)
def _layernorm(x, axis=-1, eps=1e-5):
    m = x.mean(dim=axis, keepdim=True)
    v = x.var(dim=axis, keepdim=True, unbiased=False)
    return (x - m) / torch.sqrt(v + eps)
def _scatter_add(tgt, idx, src, axis=0):
    return tgt.clone().index_add_(axis, idx, src)
def _segment_sum(src, seg, n):
    out = torch.zeros((n,) + src.shape[1:], dtype=src.dtype)
    return out.index_add_(0, seg, src)
def _pad(x, pw):
    flat = tuple(v for pair in reversed(pw) for v in pair)
    return torch.nn.functional.pad(x, flat)

kernel_name = 'concat_heads__ssm_conv_s4__softmax_full_mha__prompt'

def setup_inputs():

    _w = (lambda a: (lambda t: t.to(torch.bfloat16) if t.is_floating_point() else t)(torch.as_tensor(a)))
    def _A_setup():
        B, L, D, N = 1, 2048, 448, 256
        A_re = -(lambda _x: torch.exp(torch.as_tensor(_x)))((lambda *s: torch.randn(*s, dtype=torch.bfloat16) * 3.2)(D, N))
        A_im = torch.pi * (lambda *s: torch.randn(*s, dtype=torch.bfloat16) * 0.05)(D, N)
        B_re = (lambda *s: torch.randn(*s, dtype=torch.bfloat16) * 0.2)(D, N)
        B_im = (lambda *s: torch.randn(*s, dtype=torch.bfloat16) * 0.2)(D, N)
        C_re = (lambda *s: torch.randn(*s, dtype=torch.bfloat16) * 0.2)(D, N)
        C_im = (lambda *s: torch.randn(*s, dtype=torch.bfloat16) * 0.2)(D, N)
        log_dt = (lambda *s: torch.randn(*s, dtype=torch.bfloat16) * 0.05)(D) * 0.5 - 4.0
        Dskip = (lambda *s: torch.randn(*s, dtype=torch.bfloat16) * 0.1)(D)
        return {
            "u": _w((lambda *s: torch.randn(*s, dtype=torch.bfloat16) * 0.05)(B, L, D)),
            "A_re": _w(A_re),
            "A_im": _w(A_im),
            "B_re": _w(B_re),
            "B_im": _w(B_im),
            "C_re": _w(C_re),
            "C_im": _w(C_im),
            "log_dt": _w(log_dt),
            "Dskip": _w(Dskip),
        }
    _A_in = _A_setup()

    def _B_setup():
        B, S, D = 1, 2048, 448
        return {
            "x": _w((lambda *s: torch.randn(*s, dtype=torch.bfloat16) * 0.2)(B, S, D)),
            "wqkv": _w((lambda *s: torch.randn(*s, dtype=torch.bfloat16) * 0.2)(D, 3 * D)),
            "wo": _w((lambda *s: torch.randn(*s, dtype=torch.bfloat16) * 0.05)(D, D)),
        }
    _B_in = _B_setup()

    return {
        "A_u": _A_in["u"],
        "A_A_re": _A_in["A_re"],
        "A_A_im": _A_in["A_im"],
        "A_B_re": _A_in["B_re"],
        "A_B_im": _A_in["B_im"],
        "A_C_re": _A_in["C_re"],
        "A_C_im": _A_in["C_im"],
        "A_log_dt": _A_in["log_dt"],
        "A_Dskip": _A_in["Dskip"],
        "B_x": _B_in["x"],
        "B_wqkv": _B_in["wqkv"],
        "B_wo": _B_in["wo"],
    }

def reference(A_u, A_A_re, A_A_im, A_B_re, A_B_im, A_C_re, A_C_im, A_log_dt, A_Dskip, B_x, B_wqkv, B_wo):
    def _A_ref(u, A_re, A_im, B_re, B_im, C_re, C_im, log_dt, Dskip):
        Bsz, L, D = u.shape
        dt = torch.exp(log_dt)[:, None]
        A = A_re + 1j * A_im
        Bc = B_re + 1j * B_im
        Cc = C_re + 1j * C_im
        logdA = dt * A
        dB = dt * Bc
        l = (lambda x, dt: x.to(dt))(torch.arange(L), A_re.dtype)
        P = torch.exp(logdA[:, :, None] * l[None, None, :])
        K = torch.einsum("dn,dnl,dn->dl", Cc, P, dB).real
        L2 = 2 * L
        Kp = _pad(K, ((0, 0), (0, L)))
        up = (lambda x, *d: x.permute(*d))(u, 0, 2, 1)
        up = _pad(up, ((0, 0), (0, 0), (0, L)))
        Kf = (lambda x, axes=(-2,-1): torch.fft.rfft2(x.float(), dim=axes))(Kp[:, None, :], axes=(-2, -1))
        Uf = (lambda x, axes=(-2,-1): torch.fft.rfft2(x.float(), dim=axes))(up[:, :, None, :], axes=(-2, -1))
        Yf = Uf * Kf[None, :, :, :]
        y = (lambda x, s, axes=(-2,-1): torch.fft.irfft2(x, s=s, dim=axes).to(torch.bfloat16))(Yf, (1, L2), axes=(-2, -1))[:, :, 0, :L]
        y = (lambda x, *d: x.permute(*d))(y, 0, 2, 1) + u * Dskip[None, None, :]
        return y

    def _B_ref(x, wqkv, wo):
        B, S, D = x.shape
        H = 16; Dh = D // H
        qkv = (lambda x, *d: x.permute(*d))((x @ wqkv).reshape(B, S, 3, H, Dh), 2, 0, 3, 1, 4)
        q, k, v = qkv[0], qkv[1], qkv[2]
        scale = Dh ** -0.5
        scores = torch.einsum("bhqd,bhkd->bhqk", q, k) * scale
        p = _softmax(scores, axis=-1)
        o = torch.einsum("bhqk,bhkd->bhqd", p, v)
        return (lambda x, *d: x.permute(*d))(o, 0, 2, 1, 3).reshape(B, S, D) @ wo

    a = _A_ref(A_u, A_A_re, A_A_im, A_B_re, A_B_im, A_C_re, A_C_im, A_log_dt, A_Dskip)
    b = _B_ref(B_x, B_wqkv, B_wo)
    return torch.concatenate([a, b], axis=-1)
```

```asm
; @launch grid=(256,1,1) block=(512,1,1) lds=161792
.amdgcn_target "amdgcn-amd-amdhsa--gfx950"
.text
.globl concat_heads__ssm_conv_s4__softmax_full_mha__prompt_kernel
.p2align 11
    s_endpgm
.p2align 8
    s_endpgm
.p2align 8
    s_endpgm
.p2align 8
    s_endpgm
.p2align 8
    s_endpgm
.p2align 8
.p2align 8
.type concat_heads__ssm_conv_s4__softmax_full_mha__prompt_kernel,@function
concat_heads__ssm_conv_s4__softmax_full_mha__prompt_kernel:
    s_cmp_ge_u32 s2, 256
    s_cbranch_scc1 L_end
    s_load_dwordx16 s[16:31], s[0:1], 0
    s_load_dwordx8 s[32:39], s[0:1], 64
    s_load_dwordx4 s[40:43], s[0:1], 96
    s_load_dwordx2 s[44:45], s[0:1], 112
    s_getpc_b64 s[10:11]
    s_bfe_u32 s12, s2, 0x50003
    s_mul_i32 s12, s12, 8
    v_add_u32 v8, s12, v0
    v_lshlrev_b32 v8, 7, v8
    v_min_u32 v8, 30988, v8
    v_cmp_gt_u32 vcc, 8, v0
    s_nop 0
    s_cbranch_vccz L_npf
    s_mov_b64 exec, vcc
    global_load_dword v7, v8, s[10:11]
    s_mov_b64 exec, -1
L_npf:
    v_lshrrev_b32 v2, 6, v0
    v_and_b32 v1, 63, v0
    v_readfirstlane_b32 s3, v2
    v_cmp_gt_u32 vcc, 0x100, v0
    s_nop 1
    v_cndmask_b32 v10, 0, 1, vcc
    v_mov_b32 v11, v10
    v_lshlrev_b32 v3, 3, v0
    v_add_u32 v3, 157696, v3
    ds_write_b64 v3, v[10:11]
    v_lshlrev_b32 v4, 2, v1
    v_add_u32 v4, 157696, v4
    v_lshlrev_b32 v5, 4, v1
    v_mov_b32 v6, 1
    s_mov_b32 s46, 0
    s_and_b32 s4, s2, 7
    s_lshr_b32 s5, s2, 3
    s_and_b32 s6, s5, 15
    s_lshr_b32 s8, s5, 4
    s_lshl_b32 s7, s8, 3
    s_add_u32 s7, s7, s4
    s_lshl_b32 s75, s4, 1
    s_add_u32 s75, s75, s8
    s_cmp_ge_u32 s3, 4
    s_cbranch_scc1 L_A0
    v_lshrrev_b32 v2, 2, v1
    v_mul_u32_u24 v2, 2688, v2
    v_and_b32 v3, 3, v1
    v_lshl_add_u32 v24, v3, 4, v2
    v_lshrrev_b32 v2, 3, v1
    v_mul_u32_u24 v20, 896, v2
    v_lshrrev_b32 v3, 4, v1
    v_xor_b32 v3, v3, v1
    v_and_b32 v3, 7, v3
    v_lshl_add_u32 v18, v3, 4, v20
    v_xor_b32 v3, 4, v3
    v_lshl_add_u32 v19, v3, 4, v20
    v_add_u32 v19, 7168, v19
    v_add_u32 v20, 14336, v18
    v_add_u32 v21, 14336, v19
    v_mul_u32_u24 v2, 2688, v2
    v_lshrrev_b32 v3, 2, v1
    v_and_b32 v3, 4, v3
    v_xor_b32 v3, v3, v1
    v_and_b32 v3, 7, v3
    v_min_u32 v3, 6, v3
    v_lshl_add_u32 v22, v3, 4, v2
    v_add_u32 v23, 21504, v22
    s_mul_i32 s8, s8, 0
    s_mul_i32 s9, s6, 1
    s_add_u32 s8, s8, s9
    s_mul_i32 s9, s4, 1
    s_add_u32 s8, s8, s9
    s_and_b32 s4, s7, 7
    s_lshr_b32 s5, s75, 1
    s_mul_i32 s9, s8, 9363
    s_lshr_b32 s9, s9, 16
    s_mul_i32 s9, s9, 7
    s_sub_u32 s64, s8, s9
    s_add_u32 s65, s64, 1
    s_cmp_eq_u32 s65, 7
    s_cselect_b32 s65, 0, s65
    s_add_u32 s66, s65, 1
    s_cmp_eq_u32 s66, 7
    s_cselect_b32 s66, 0, s66
    s_add_u32 s67, s66, 1
    s_cmp_eq_u32 s67, 7
    s_cselect_b32 s67, 0, s67
    s_add_u32 s68, s67, 1
    s_cmp_eq_u32 s68, 7
    s_cselect_b32 s68, 0, s68
    s_add_u32 s69, s68, 1
    s_cmp_eq_u32 s69, 7
    s_cselect_b32 s69, 0, s69
    s_add_u32 s70, s69, 1
    s_cmp_eq_u32 s70, 7
    s_cselect_b32 s70, 0, s70
    s_lshl_b32 s8, s6, 2
    s_add_u32 s8, s8, s3
    s_mul_i32 s9, s8, 28672
    s_mul_i32 s10, s3, 43008
    s_mul_i32 s11, s7, 112
    s_add_u32 s11, s11, s10
    s_add_u32 s11, s11, 896
    s_mul_i32 s12, s5, 112
    s_add_u32 s10, s10, s12
    s_and_b32 s12, s75, 1
    s_mul_i32 s12, s12, 48
    s_add_u32 s10, s10, s12
    s_mul_i32 s12, s3, 12288
    s_add_u32 s12, s12, 57344
    s_lshl_b32 s13, s3, 11
    s_lshl_b32 s47, s3, 9
    v_mov_b32 v25, 0x7ffffff0
    v_and_b32 v26, 3, v1
    v_lshlrev_b32 v26, 9, v26
    v_add_u32 v26, 157696, v26
    s_waitcnt lgkmcnt(0)
    s_mov_b32 s52, s34
    s_and_b32 s53, s35, 0xffff
    s_mov_b32 s54, 1835008
    s_mov_b32 s55, 0x00020000
    s_mov_b32 s56, s36
    s_and_b32 s57, s37, 0xffff
    s_mov_b32 s58, 1204224
    s_mov_b32 s59, 0x00020000
    s_cmp_lg_u32 s3, 3
    s_cbranch_scc1 co_sb1
    s_lshr_b32 s15, s2, 3
    s_and_b32 s14, s2, 7
    s_lshl_b32 s14, s14, 5
    s_add_u32 s14, s14, s15
    s_lshl_b32 s14, s14, 10
    s_min_u32 s14, s14, 228864
    s_mul_i32 s15, s15, 57344
    s_sub_u32 s15, 1820672, s15
    s_load_dword s31, s[18:19], s14
    s_load_dword s20, s[20:21], s14
    s_load_dword s22, s[22:23], s14
    s_load_dword s24, s[24:25], s14
    s_load_dword s26, s[26:27], s14
    s_load_dword s28, s[28:29], s14
    s_load_dword s30, s[16:17], s15
co_sb1:
    s_mul_i32 s15, s64, 172032
    s_add_u32 s15, s15, s11
    s_lshl_b32 s14, s64, 7
    s_add_u32 s14, s14, s9
    s_add_u32 m0, s13, 0
    s_nop 0
    buffer_load_dwordx4 v22, s[56:59], s15 offen lds
    s_add_u32 m0, s13, 1024
    s_nop 0
    buffer_load_dwordx4 v23, s[56:59], s15 offen lds
    s_mul_i32 s15, s64, 172032
    s_add_u32 s15, s15, s10
    s_lshl1_add_u32 m0, s47, 106496
    s_nop 0
    buffer_load_dwordx4 v24, s[56:59], s15 offen lds
    s_add_u32 m0, s47, 157696
    s_mov_b64 exec, 1
    buffer_load_dword v25, s[56:59], 0 offen lds
    s_mov_b64 exec, -1
    s_add_u32 m0, s12, 0
    s_nop 0
    buffer_load_dwordx4 v18, s[52:55], s14 offen lds
    s_add_u32 m0, s12, 1024
    s_nop 0
    buffer_load_dwordx4 v19, s[52:55], s14 offen lds
    s_add_u32 m0, s12, 2048
    s_nop 0
    buffer_load_dwordx4 v20, s[52:55], s14 offen lds
    s_add_u32 m0, s12, 3072
    s_nop 0
    buffer_load_dwordx4 v21, s[52:55], s14 offen lds
    s_mov_b32 s48, s44
    s_and_b32 s49, s45, 0xffff
    s_mov_b32 s50, 268435456
    s_mov_b32 s51, 0x00020000
    s_mov_b32 s60, s42
    s_and_b32 s61, s43, 0xffff
    s_mov_b32 s62, 256
    s_mov_b32 s63, 0x00020000
    s_or_b32 s14, s2, s3
    s_cmp_lg_u32 s14, 0
    s_cbranch_scc1 L_nn
    s_memrealtime s[14:15]
    s_waitcnt lgkmcnt(0)
    s_or_b32 s14, s14, 1
    v_mov_b32 v8, s14
    v_mov_b32 v9, s15
    s_mov_b64 exec, 1
    buffer_store_dwordx2 v[8:9], off, s[60:63], 0 sc1
    s_mov_b64 exec, -1
L_nn:
    s_barrier
    s_mul_i32 s15, s65, 172032
    s_add_u32 s15, s15, s11
    s_lshl_b32 s14, s65, 7
    s_add_u32 s14, s14, s9
    s_add_u32 m0, s13, 8192
    s_nop 0
    buffer_load_dwordx4 v22, s[56:59], s15 offen lds
    s_add_u32 m0, s13, 9216
    s_nop 0
    buffer_load_dwordx4 v23, s[56:59], s15 offen lds
    s_mul_i32 s15, s65, 172032
    s_add_u32 s15, s15, s10
    s_lshl1_add_u32 m0, s47, 110592
    s_nop 0
    buffer_load_dwordx4 v24, s[56:59], s15 offen lds
    s_add_u32 m0, s47, 157700
    s_mov_b64 exec, 1
    buffer_load_dword v25, s[56:59], 0 offen lds
    s_mov_b64 exec, -1
    s_add_u32 m0, s12, 4096
    s_nop 0
    buffer_load_dwordx4 v18, s[52:55], s14 offen lds
    s_add_u32 m0, s12, 5120
    s_nop 0
    buffer_load_dwordx4 v19, s[52:55], s14 offen lds
    s_add_u32 m0, s12, 6144
    s_nop 0
    buffer_load_dwordx4 v20, s[52:55], s14 offen lds
    s_add_u32 m0, s12, 7168
    s_nop 0
    buffer_load_dwordx4 v21, s[52:55], s14 offen lds
    s_branch L_B2
L_A0:
    s_sub_u32 s3, s3, 4
    s_cmp_ge_u32 s4, 7
    s_cbranch_scc1 L_A2
    s_setprio 3
    s_lshr_b32 s12, s3, 1
    s_lshl_b32 s8, s4, 5
    s_add_u32 s8, s8, s5
    s_lshl_b32 s74, s8, 2
    s_lshl_b32 s8, s8, 1
    s_add_u32 s8, s8, s12
    s_and_b32 s9, s3, 1
    s_lshl_b32 s10, s5, 2
    s_add_u32 s10, s10, s3
    s_mul_i32 s72, s12, 21120
    s_add_u32 s72, s72, 115456
    s_lshl_b32 s13, s9, 12
    s_add_u32 s13, s13, s72
    s_lshl_b32 s14, s8, 9
    s_lshl_b32 s15, s9, 8
    s_add_u32 s14, s14, s15
    v_lshl_add_u32 v3, v1, 2, s14
    s_mov_b32 s11, s14
    v_lshrrev_b32 v2, 3, v1
    v_mul_u32_u24 v2, 896, v2
    v_and_b32 v20, 7, v1
    v_lshl_add_u32 v2, v20, 4, v2
    s_mul_i32 s14, s10, 14336
    s_sub_u32 s14, 1820672, s14
    s_lshl_b32 s15, s4, 7
    s_add_u32 s14, s14, s15
    s_add_u32 s15, s14, 7168
    s_waitcnt lgkmcnt(0)
    s_load_dword s64, s[30:31], s74
    s_load_dword s65, s[32:33], s74
    s_mov_b32 s52, s16
    s_and_b32 s53, s17, 0xffff
    s_mov_b32 s54, 1835008
    s_mov_b32 s55, 0x00020000
    s_mov_b32 m0, s13
    s_nop 0
    buffer_load_dwordx4 v2, s[52:55], s14 offen lds
    s_add_u32 m0, s13, 1024
    s_nop 0
    buffer_load_dwordx4 v2, s[52:55], s15 offen lds
    global_load_dword v12, v3, s[18:19]
    global_load_dword v13, v3, s[20:21]
    global_load_dword v14, v3, s[22:23]
    global_load_dword v15, v3, s[24:25]
    global_load_dword v16, v3, s[26:27]
    global_load_dword v17, v3, s[28:29]
    s_barrier
    s_branch L_A
L_B2:
    s_setprio 1
    v_and_b32 v2, 31, v1
    v_lshl_add_u32 v2, v2, 7, s12
    v_bfe_u32 v3, v1, 1, 3
    v_lshrrev_b32 v241, 5, v1
    v_xor_b32 v3, v3, v241
    v_lshl_add_u32 v240, v3, 4, v2
    v_xor_b32 v241, 32, v240
    v_xor_b32 v242, 64, v240
    v_xor_b32 v243, 96, v240
    v_lshrrev_b32 v2, 5, v1
    v_bfe_u32 v3, v1, 2, 2
    v_lshl_add_u32 v2, v2, 3, v3
    v_bfe_u32 v3, v1, 4, 1
    v_lshlrev_b32 v3, 2, v3
    v_and_or_b32 v3, v1, 3, v3
    v_lshlrev_b32 v3, 3, v3
    s_and_b32 s14, s75, 1
    s_lshl_b32 s14, s14, 3
    s_add_u32 s14, s14, 106496
    v_lshl_add_u32 v246, v2, 6, v3
    v_add_u32 v246, s14, v246
    v_and_b32 v247, 8, v1
    v_lshlrev_b32 v247, 3, v247
    v_xor_b32 v244, v3, v247
    v_add_u32 v3, 56, v3
    v_xor_b32 v245, v3, v247
    v_lshl_add_u32 v244, v2, 7, v244
    v_lshl_add_u32 v245, v2, 7, v245
    v_cmp_gt_u32 vcc, 32, v1
    s_nop 1
    v_cndmask_b32 v15, 0, -1, vcc
    v_and_b32 v2, 15, v1
    v_and_b32 v3, 32, v1
    v_lshlrev_b32 v3, 4, v3
    v_lshl_add_u32 v16, v2, 3, v3
    s_lshl_b32 s71, s4, 7
    s_add_u32 s71, s71, s8
    s_lshl_b32 s71, s71, 12
    s_add_u32 s71, s71, 2097152
    s_add_u32 s72, s71, 0x40000
    s_lshl_b32 s74, s4, 12
    s_add_u32 s74, s74, 14680064
    s_and_b32 s73, s7, 8
    s_lshl_b32 s73, s73, 3
    s_lshl_b32 s14, s3, 4
    s_add_u32 s73, s73, s14
    s_add_u32 s73, s73, s6
    s_lshl_b32 s73, s73, 3
    s_add_u32 s73, s73, s74
    s_lshl_b32 s74, s5, 5
    s_add_u32 s74, s74, s3
    s_lshl_b32 s74, s74, 7
    s_add_u32 s74, s74, 14680064
    s_lshl_b32 s14, s75, 6
    s_add_u32 s14, s14, s3
    s_lshl_b32 s14, s14, 12
    s_add_u32 s14, s14, 2097152
    v_add_u32 v17, s14, v5
    s_mul_i32 s14, s6, 1
    s_add_u32 s14, s14, 1
    s_and_b32 s14, s14, 15
    s_lshl_b32 s17, 65535, s14
    s_mov_b32 s19, 0
    s_cmp_ge_u32 s7, 8
    s_cbranch_scc1 L_V
    v_and_b32 v2, 0x33, v1
    v_bfe_u32 v3, v1, 2, 1
    v_lshl_add_u32 v2, v3, 3, v2
    v_bfe_u32 v3, v1, 3, 1
    v_lshl_add_u32 v2, v3, 2, v2
    v_lshlrev_b32 v14, 4, v2
    s_waitcnt vmcnt(8)
    ds_read_b128 v[112:115], v240 offset:0
    ds_read_b128 v[116:119], v241 offset:0
    ds_read_b128 v[120:123], v242 offset:0
    ds_read_b128 v[124:127], v243 offset:0
    ds_read_b32 v7, v26 offset:0
    s_mul_i32 s15, s66, 172032
    s_add_u32 s15, s15, s11
    s_lshl_b32 s14, s66, 7
    s_add_u32 s14, s14, s9
    s_add_u32 m0, s13, 16384
    s_nop 0
    buffer_load_dwordx4 v22, s[56:59], s15 offen lds
    s_add_u32 m0, s13, 17408
    s_nop 0
    buffer_load_dwordx4 v23, s[56:59], s15 offen lds
    s_mul_i32 s15, s66, 172032
    s_add_u32 s15, s15, s10
    s_lshl1_add_u32 m0, s47, 123648
    s_nop 0
    buffer_load_dwordx4 v24, s[56:59], s15 offen lds
    s_add_u32 m0, s47, 157704
    s_mov_b64 exec, 1
    buffer_load_dword v25, s[56:59], 0 offen lds
    s_mov_b64 exec, -1
    s_add_u32 m0, s12, 8192
    s_nop 0
    buffer_load_dwordx4 v18, s[52:55], s14 offen lds
    s_add_u32 m0, s12, 9216
    s_nop 0
    buffer_load_dwordx4 v19, s[52:55], s14 offen lds
    s_add_u32 m0, s12, 10240
    s_nop 0
    buffer_load_dwordx4 v20, s[52:55], s14 offen lds
    s_add_u32 m0, s12, 11264
    s_nop 0
    buffer_load_dwordx4 v21, s[52:55], s14 offen lds
    s_waitcnt lgkmcnt(0)
    v_cmp_ne_u32 vcc, 0, v7
    s_nop 0
    s_cbranch_vccnz co_sp2
co_ok3:
    ds_read_b64_tr_b16 v[192:193], v244 offset:0
    ds_read_b64_tr_b16 v[194:195], v244 offset:512
    ds_read_b64_tr_b16 v[208:209], v245 offset:0
    ds_read_b64_tr_b16 v[210:211], v245 offset:512
    ds_read_b64_tr_b16 v[224:225], v246 offset:0
    ds_read_b64_tr_b16 v[226:227], v246 offset:256
    ds_read_b64_tr_b16 v[196:197], v244 offset:2048
    ds_read_b64_tr_b16 v[198:199], v244 offset:2560
    ds_read_b64_tr_b16 v[212:213], v245 offset:2048
    ds_read_b64_tr_b16 v[214:215], v245 offset:2560
    ds_read_b64_tr_b16 v[228:229], v246 offset:1024
    ds_read_b64_tr_b16 v[230:231], v246 offset:1280
    s_waitcnt lgkmcnt(10)
    v_mfma_f32_32x32x16_bf16 v[160:175], v[192:195], v[112:115], 0
    ds_read_b64_tr_b16 v[200:201], v244 offset:4096
    ds_read_b64_tr_b16 v[202:203], v244 offset:4608
    s_waitcnt lgkmcnt(10)
    v_mfma_f32_32x32x16_bf16 v[176:191], v[208:211], v[112:115], 0
    ds_read_b64_tr_b16 v[216:217], v245 offset:4096
    ds_read_b64_tr_b16 v[218:219], v245 offset:4608
    s_waitcnt lgkmcnt(10)
    v_mfma_f32_32x32x16_bf16 v[96:111], v[224:227], v[112:115], 0
    ds_read_b64_tr_b16 v[232:233], v246 offset:2048
    ds_read_b64_tr_b16 v[234:235], v246 offset:2304
    s_waitcnt lgkmcnt(10)
    v_mfma_f32_32x32x16_bf16 v[160:175], v[196:199], v[116:119], v[160:175]
    ds_read_b64_tr_b16 v[204:205], v244 offset:6144
    ds_read_b64_tr_b16 v[206:207], v244 offset:6656
    ds_read_b32 v7, v26 offset:4
    s_waitcnt lgkmcnt(11)
    v_mfma_f32_32x32x16_bf16 v[176:191], v[212:215], v[116:119], v[176:191]
    ds_read_b64_tr_b16 v[220:221], v245 offset:6144
    ds_read_b64_tr_b16 v[222:223], v245 offset:6656
    s_mul_i32 s15, s67, 172032
    s_add_u32 s15, s15, s11
    s_add_u32 m0, s13, 24576
    s_lshl_b32 s14, s67, 7
    buffer_load_dwordx4 v22, s[56:59], s15 offen lds
    s_waitcnt lgkmcnt(11)
    v_mfma_f32_32x32x16_bf16 v[96:111], v[228:231], v[116:119], v[96:111]
    ds_read_b64_tr_b16 v[236:237], v246 offset:3072
    ds_read_b64_tr_b16 v[238:239], v246 offset:3328
    s_add_u32 m0, s13, 25600
    s_add_u32 s14, s14, s9
    buffer_load_dwordx4 v23, s[56:59], s15 offen lds
    s_waitcnt lgkmcnt(4)
    v_cmp_ne_u32 vcc, 0, v7
    s_nop 0
    s_cbranch_vccnz co_sp4
co_ok5:
    s_waitcnt vmcnt(10)
    v_mfma_f32_32x32x16_bf16 v[160:175], v[200:203], v[120:123], v[160:175]
    ds_read_b64_tr_b16 v[192:193], v244 offset:8192
    ds_read_b64_tr_b16 v[194:195], v244 offset:8704
    ds_read_b128 v[128:131], v240 offset:4096
    s_mul_i32 s15, s67, 172032
    s_add_u32 s15, s15, s10
    s_lshl1_add_u32 m0, s47, 127744
    s_nop 0
    buffer_load_dwordx4 v24, s[56:59], s15 offen lds
    v_mfma_f32_32x32x16_bf16 v[176:191], v[216:219], v[120:123], v[176:191]
    ds_read_b64_tr_b16 v[208:209], v245 offset:8192
    ds_read_b64_tr_b16 v[210:211], v245 offset:8704
    ds_read_b128 v[132:135], v241 offset:4096
    s_add_u32 m0, s47, 157708
    s_mov_b64 exec, 1
    buffer_load_dword v25, s[56:59], 0 offen lds
    s_mov_b64 exec, -1
    v_mfma_f32_32x32x16_bf16 v[96:111], v[232:235], v[120:123], v[96:111]
    ds_read_b64_tr_b16 v[224:225], v246 offset:4096
    ds_read_b64_tr_b16 v[226:227], v246 offset:4352
    ds_read_b128 v[136:139], v242 offset:4096
    s_add_u32 m0, s12, 0
    s_nop 0
    buffer_load_dwordx4 v18, s[52:55], s14 offen lds
    v_mfma_f32_32x32x16_bf16 v[160:175], v[204:207], v[124:127], v[160:175]
    ds_read_b64_tr_b16 v[196:197], v244 offset:10240
    ds_read_b64_tr_b16 v[198:199], v244 offset:10752
    ds_read_b128 v[140:143], v243 offset:4096
    s_add_u32 m0, s12, 1024
    s_nop 0
    buffer_load_dwordx4 v19, s[52:55], s14 offen lds
    s_waitcnt lgkmcnt(14)
    v_mfma_f32_32x32x16_bf16 v[176:191], v[220:223], v[124:127], v[176:191]
    ds_read_b64_tr_b16 v[212:213], v245 offset:10240
    ds_read_b64_tr_b16 v[214:215], v245 offset:10752
    s_add_u32 m0, s12, 2048
    s_nop 0
    buffer_load_dwordx4 v20, s[52:55], s14 offen lds
    s_waitcnt lgkmcnt(14)
    v_mfma_f32_32x32x16_bf16 v[96:111], v[236:239], v[124:127], v[96:111]
    ds_read_b64_tr_b16 v[228:229], v246 offset:5120
    ds_read_b64_tr_b16 v[230:231], v246 offset:5376
    s_add_u32 m0, s12, 3072
    s_nop 0
    buffer_load_dwordx4 v21, s[52:55], s14 offen lds
    s_waitcnt lgkmcnt(13)
    v_mfma_f32_32x32x16_bf16 v[160:175], v[192:195], v[128:131], v[160:175]
    ds_read_b64_tr_b16 v[200:201], v244 offset:12288
    ds_read_b64_tr_b16 v[202:203], v244 offset:12800
    s_waitcnt lgkmcnt(13)
    v_mfma_f32_32x32x16_bf16 v[176:191], v[208:211], v[128:131], v[176:191]
    ds_read_b64_tr_b16 v[216:217], v245 offset:12288
    ds_read_b64_tr_b16 v[218:219], v245 offset:12800
    s_waitcnt lgkmcnt(12)
    v_mfma_f32_32x32x16_bf16 v[96:111], v[224:227], v[128:131], v[96:111]
    ds_read_b64_tr_b16 v[232:233], v246 offset:6144
    ds_read_b64_tr_b16 v[234:235], v246 offset:6400
    s_waitcnt lgkmcnt(11)
    v_mfma_f32_32x32x16_bf16 v[160:175], v[196:199], v[132:135], v[160:175]
    ds_read_b64_tr_b16 v[204:205], v244 offset:14336
    ds_read_b64_tr_b16 v[206:207], v244 offset:14848
    ds_read_b32 v7, v26 offset:8
    s_waitcnt lgkmcnt(11)
    v_mfma_f32_32x32x16_bf16 v[176:191], v[212:215], v[132:135], v[176:191]
    ds_read_b64_tr_b16 v[220:221], v245 offset:14336
    ds_read_b64_tr_b16 v[222:223], v245 offset:14848
    s_mul_i32 s15, s68, 172032
    s_add_u32 s15, s15, s11
    s_add_u32 m0, s13, 32768
    s_lshl_b32 s14, s68, 7
    buffer_load_dwordx4 v22, s[56:59], s15 offen lds
    s_waitcnt lgkmcnt(11)
    v_mfma_f32_32x32x16_bf16 v[96:111], v[228:231], v[132:135], v[96:111]
    ds_read_b64_tr_b16 v[236:237], v246 offset:7168
    ds_read_b64_tr_b16 v[238:239], v246 offset:7424
    s_add_u32 m0, s13, 33792
    s_add_u32 s14, s14, s9
    buffer_load_dwordx4 v23, s[56:59], s15 offen lds
    s_waitcnt lgkmcnt(4)
    v_cmp_ne_u32 vcc, 0, v7
    s_nop 0
    s_cbranch_vccnz co_sp6
co_ok7:
    s_waitcnt vmcnt(10)
    v_mfma_f32_32x32x16_bf16 v[160:175], v[200:203], v[136:139], v[160:175]
    ds_read_b64_tr_b16 v[192:193], v244 offset:16384
    ds_read_b64_tr_b16 v[194:195], v244 offset:16896
    ds_read_b128 v[112:115], v240 offset:8192
    s_mul_i32 s15, s68, 172032
    s_add_u32 s15, s15, s10
    s_lshl1_add_u32 m0, s47, 131840
    s_nop 0
    buffer_load_dwordx4 v24, s[56:59], s15 offen lds
    v_mfma_f32_32x32x16_bf16 v[176:191], v[216:219], v[136:139], v[176:191]
    ds_read_b64_tr_b16 v[208:209], v245 offset:16384
    ds_read_b64_tr_b16 v[210:211], v245 offset:16896
    ds_read_b128 v[116:119], v241 offset:8192
    s_add_u32 m0, s47, 157712
    s_mov_b64 exec, 1
    buffer_load_dword v25, s[56:59], 0 offen lds
    s_mov_b64 exec, -1
    v_mfma_f32_32x32x16_bf16 v[96:111], v[232:235], v[136:139], v[96:111]
    ds_read_b64_tr_b16 v[224:225], v246 offset:17152
    ds_read_b64_tr_b16 v[226:227], v246 offset:17408
    ds_read_b128 v[120:123], v242 offset:8192
    s_add_u32 m0, s12, 4096
    s_nop 0
    buffer_load_dwordx4 v18, s[52:55], s14 offen lds
    v_mfma_f32_32x32x16_bf16 v[160:175], v[204:207], v[140:143], v[160:175]
    ds_read_b64_tr_b16 v[196:197], v244 offset:18432
    ds_read_b64_tr_b16 v[198:199], v244 offset:18944
    ds_read_b128 v[124:127], v243 offset:8192
    s_add_u32 m0, s12, 5120
    s_nop 0
    buffer_load_dwordx4 v19, s[52:55], s14 offen lds
    s_waitcnt lgkmcnt(14)
    v_mfma_f32_32x32x16_bf16 v[176:191], v[220:223], v[140:143], v[176:191]
    ds_read_b64_tr_b16 v[212:213], v245 offset:18432
    ds_read_b64_tr_b16 v[214:215], v245 offset:18944
    s_add_u32 m0, s12, 6144
    s_nop 0
    buffer_load_dwordx4 v20, s[52:55], s14 offen lds
    s_waitcnt lgkmcnt(14)
    v_mfma_f32_32x32x16_bf16 v[96:111], v[236:239], v[140:143], v[96:111]
    ds_read_b64_tr_b16 v[228:229], v246 offset:18176
    ds_read_b64_tr_b16 v[230:231], v246 offset:18432
    s_add_u32 m0, s12, 7168
    s_nop 0
    buffer_load_dwordx4 v21, s[52:55], s14 offen lds
    s_waitcnt lgkmcnt(13)
    v_mfma_f32_32x32x16_bf16 v[160:175], v[192:195], v[112:115], v[160:175]
    ds_read_b64_tr_b16 v[200:201], v244 offset:20480
    ds_read_b64_tr_b16 v[202:203], v244 offset:20992
    s_waitcnt lgkmcnt(13)
    v_mfma_f32_32x32x16_bf16 v[176:191], v[208:211], v[112:115], v[176:191]
    ds_read_b64_tr_b16 v[216:217], v245 offset:20480
    ds_read_b64_tr_b16 v[218:219], v245 offset:20992
    s_waitcnt lgkmcnt(12)
    v_mfma_f32_32x32x16_bf16 v[96:111], v[224:227], v[112:115], v[96:111]
    ds_read_b64_tr_b16 v[232:233], v246 offset:19200
    ds_read_b64_tr_b16 v[234:235], v246 offset:19456
    s_waitcnt lgkmcnt(11)
    v_mfma_f32_32x32x16_bf16 v[160:175], v[196:199], v[116:119], v[160:175]
    ds_read_b64_tr_b16 v[204:205], v244 offset:22528
    ds_read_b64_tr_b16 v[206:207], v244 offset:23040
    ds_read_b32 v7, v26 offset:12
    s_waitcnt lgkmcnt(11)
    v_mfma_f32_32x32x16_bf16 v[176:191], v[212:215], v[116:119], v[176:191]
    ds_read_b64_tr_b16 v[220:221], v245 offset:22528
    ds_read_b64_tr_b16 v[222:223], v245 offset:23040
    s_mul_i32 s15, s69, 172032
    s_add_u32 s15, s15, s11
    s_add_u32 m0, s13, 40960
    s_lshl_b32 s14, s69, 7
    buffer_load_dwordx4 v22, s[56:59], s15 offen lds
    s_waitcnt lgkmcnt(11)
    v_mfma_f32_32x32x16_bf16 v[96:111], v[228:231], v[116:119], v[96:111]
    ds_read_b64_tr_b16 v[236:237], v246 offset:20224
    ds_read_b64_tr_b16 v[238:239], v246 offset:20480
    s_add_u32 m0, s13, 41984
    s_add_u32 s14, s14, s9
    buffer_load_dwordx4 v23, s[56:59], s15 offen lds
    s_waitcnt lgkmcnt(4)
    v_cmp_ne_u32 vcc, 0, v7
    s_nop 0
    s_cbranch_vccnz co_sp8
co_ok9:
    s_waitcnt vmcnt(10)
    v_mfma_f32_32x32x16_bf16 v[160:175], v[200:203], v[120:123], v[160:175]
    ds_read_b64_tr_b16 v[192:193], v244 offset:24576
    ds_read_b64_tr_b16 v[194:195], v244 offset:25088
    ds_read_b128 v[128:131], v240 offset:0
    s_mul_i32 s15, s69, 172032
    s_add_u32 s15, s15, s10
    s_lshl1_add_u32 m0, s47, 144768
    s_nop 0
    buffer_load_dwordx4 v24, s[56:59], s15 offen lds
    v_mfma_f32_32x32x16_bf16 v[176:191], v[216:219], v[120:123], v[176:191]
    ds_read_b64_tr_b16 v[208:209], v245 offset:24576
    ds_read_b64_tr_b16 v[210:211], v245 offset:25088
    ds_read_b128 v[132:135], v241 offset:0
    s_add_u32 m0, s47, 157716
    s_mov_b64 exec, 1
    buffer_load_dword v25, s[56:59], 0 offen lds
    s_mov_b64 exec, -1
    v_mfma_f32_32x32x16_bf16 v[96:111], v[232:235], v[120:123], v[96:111]
    ds_read_b64_tr_b16 v[224:225], v246 offset:21248
    ds_read_b64_tr_b16 v[226:227], v246 offset:21504
    ds_read_b128 v[136:139], v242 offset:0
    s_add_u32 m0, s12, 8192
    s_nop 0
    buffer_load_dwordx4 v18, s[52:55], s14 offen lds
    v_mfma_f32_32x32x16_bf16 v[160:175], v[204:207], v[124:127], v[160:175]
    ds_read_b64_tr_b16 v[196:197], v244 offset:26624
    ds_read_b64_tr_b16 v[198:199], v244 offset:27136
    ds_read_b128 v[140:143], v243 offset:0
    s_add_u32 m0, s12, 9216
    s_nop 0
    buffer_load_dwordx4 v19, s[52:55], s14 offen lds
    s_waitcnt lgkmcnt(14)
    v_mfma_f32_32x32x16_bf16 v[176:191], v[220:223], v[124:127], v[176:191]
    ds_read_b64_tr_b16 v[212:213], v245 offset:26624
    ds_read_b64_tr_b16 v[214:215], v245 offset:27136
    s_add_u32 m0, s12, 10240
    s_nop 0
    buffer_load_dwordx4 v20, s[52:55], s14 offen lds
    s_waitcnt lgkmcnt(14)
    v_mfma_f32_32x32x16_bf16 v[96:111], v[236:239], v[124:127], v[96:111]
    ds_read_b64_tr_b16 v[228:229], v246 offset:22272
    ds_read_b64_tr_b16 v[230:231], v246 offset:22528
    s_add_u32 m0, s12, 11264
    s_nop 0
    buffer_load_dwordx4 v21, s[52:55], s14 offen lds
    s_waitcnt lgkmcnt(13)
    v_mfma_f32_32x32x16_bf16 v[160:175], v[192:195], v[128:131], v[160:175]
    ds_read_b64_tr_b16 v[200:201], v244 offset:28672
    ds_read_b64_tr_b16 v[202:203], v244 offset:29184
    s_waitcnt lgkmcnt(13)
    v_mfma_f32_32x32x16_bf16 v[176:191], v[208:211], v[128:131], v[176:191]
    ds_read_b64_tr_b16 v[216:217], v245 offset:28672
    ds_read_b64_tr_b16 v[218:219], v245 offset:29184
    s_waitcnt lgkmcnt(12)
    v_mfma_f32_32x32x16_bf16 v[96:111], v[224:227], v[128:131], v[96:111]
    ds_read_b64_tr_b16 v[232:233], v246 offset:23296
    ds_read_b64_tr_b16 v[234:235], v246 offset:23552
    s_waitcnt lgkmcnt(11)
    v_mfma_f32_32x32x16_bf16 v[160:175], v[196:199], v[132:135], v[160:175]
    ds_read_b64_tr_b16 v[204:205], v244 offset:30720
    ds_read_b64_tr_b16 v[206:207], v244 offset:31232
    ds_read_b32 v7, v26 offset:16
    s_waitcnt lgkmcnt(11)
    v_mfma_f32_32x32x16_bf16 v[176:191], v[212:215], v[132:135], v[176:191]
    ds_read_b64_tr_b16 v[220:221], v245 offset:30720
    ds_read_b64_tr_b16 v[222:223], v245 offset:31232
    s_mul_i32 s15, s70, 172032
    s_add_u32 s15, s15, s11
    s_add_u32 m0, s13, 49152
    s_lshl_b32 s14, s70, 7
    buffer_load_dwordx4 v22, s[56:59], s15 offen lds
    s_waitcnt lgkmcnt(11)
    v_mfma_f32_32x32x16_bf16 v[96:111], v[228:231], v[132:135], v[96:111]
    ds_read_b64_tr_b16 v[236:237], v246 offset:24320
    ds_read_b64_tr_b16 v[238:239], v246 offset:24576
    s_add_u32 m0, s13, 50176
    s_add_u32 s14, s14, s9
    buffer_load_dwordx4 v23, s[56:59], s15 offen lds
    s_waitcnt lgkmcnt(4)
    v_cmp_ne_u32 vcc, 0, v7
    s_nop 0
    s_cbranch_vccnz co_sp10
co_ok11:
    s_waitcnt vmcnt(10)
    v_mfma_f32_32x32x16_bf16 v[160:175], v[200:203], v[136:139], v[160:175]
    ds_read_b64_tr_b16 v[192:193], v244 offset:32768
    ds_read_b64_tr_b16 v[194:195], v244 offset:33280
    ds_read_b128 v[112:115], v240 offset:4096
    s_mul_i32 s15, s70, 172032
    s_add_u32 s15, s15, s10
    s_lshl1_add_u32 m0, s47, 148864
    s_nop 0
    buffer_load_dwordx4 v24, s[56:59], s15 offen lds
    v_mfma_f32_32x32x16_bf16 v[176:191], v[216:219], v[136:139], v[176:191]
    ds_read_b64_tr_b16 v[208:209], v245 offset:32768
    ds_read_b64_tr_b16 v[210:211], v245 offset:33280
    ds_read_b128 v[116:119], v241 offset:4096
    s_add_u32 m0, s47, 157720
    s_mov_b64 exec, 1
    buffer_load_dword v25, s[56:59], 0 offen lds
    s_mov_b64 exec, -1
    v_mfma_f32_32x32x16_bf16 v[96:111], v[232:235], v[136:139], v[96:111]
    ds_read_b64_tr_b16 v[224:225], v246 offset:25344
    ds_read_b64_tr_b16 v[226:227], v246 offset:25600
    ds_read_b128 v[120:123], v242 offset:4096
    s_add_u32 m0, s12, 0
    s_nop 0
    buffer_load_dwordx4 v18, s[52:55], s14 offen lds
    v_mfma_f32_32x32x16_bf16 v[160:175], v[204:207], v[140:143], v[160:175]
    ds_read_b64_tr_b16 v[196:197], v244 offset:34816
    ds_read_b64_tr_b16 v[198:199], v244 offset:35328
    ds_read_b128 v[124:127], v243 offset:4096
    s_add_u32 m0, s12, 1024
    s_nop 0
    buffer_load_dwordx4 v19, s[52:55], s14 offen lds
    s_waitcnt lgkmcnt(14)
    v_mfma_f32_32x32x16_bf16 v[176:191], v[220:223], v[140:143], v[176:191]
    ds_read_b64_tr_b16 v[212:213], v245 offset:34816
    ds_read_b64_tr_b16 v[214:215], v245 offset:35328
    s_add_u32 m0, s12, 2048
    s_nop 0
    buffer_load_dwordx4 v20, s[52:55], s14 offen lds
    s_waitcnt lgkmcnt(14)
    v_mfma_f32_32x32x16_bf16 v[96:111], v[236:239], v[140:143], v[96:111]
    ds_read_b64_tr_b16 v[228:229], v246 offset:26368
    ds_read_b64_tr_b16 v[230:231], v246 offset:26624
    s_add_u32 m0, s12, 3072
    s_nop 0
    buffer_load_dwordx4 v21, s[52:55], s14 offen lds
    s_waitcnt lgkmcnt(13)
    v_mfma_f32_32x32x16_bf16 v[160:175], v[192:195], v[112:115], v[160:175]
    ds_read_b64_tr_b16 v[200:201], v244 offset:36864
    ds_read_b64_tr_b16 v[202:203], v244 offset:37376
    s_waitcnt lgkmcnt(13)
    v_mfma_f32_32x32x16_bf16 v[176:191], v[208:211], v[112:115], v[176:191]
    ds_read_b64_tr_b16 v[216:217], v245 offset:36864
    ds_read_b64_tr_b16 v[218:219], v245 offset:37376
    s_waitcnt lgkmcnt(12)
    v_mfma_f32_32x32x16_bf16 v[96:111], v[224:227], v[112:115], v[96:111]
    ds_read_b64_tr_b16 v[232:233], v246 offset:27392
    ds_read_b64_tr_b16 v[234:235], v246 offset:27648
    s_waitcnt lgkmcnt(11)
    v_mfma_f32_32x32x16_bf16 v[160:175], v[196:199], v[116:119], v[160:175]
    ds_read_b64_tr_b16 v[204:205], v244 offset:38912
    ds_read_b64_tr_b16 v[206:207], v244 offset:39424
    ds_read_b32 v7, v26 offset:20
    s_waitcnt lgkmcnt(11)
    v_mfma_f32_32x32x16_bf16 v[176:191], v[212:215], v[116:119], v[176:191]
    ds_read_b64_tr_b16 v[220:221], v245 offset:38912
    ds_read_b64_tr_b16 v[222:223], v245 offset:39424
    s_waitcnt lgkmcnt(11)
    v_mfma_f32_32x32x16_bf16 v[96:111], v[228:231], v[116:119], v[96:111]
    ds_read_b64_tr_b16 v[236:237], v246 offset:28416
    ds_read_b64_tr_b16 v[238:239], v246 offset:28672
    s_waitcnt lgkmcnt(4)
    v_cmp_ne_u32 vcc, 0, v7
    s_nop 0
    s_cbranch_vccnz co_sp12
co_ok13:
    s_waitcnt vmcnt(8)
    v_mfma_f32_32x32x16_bf16 v[160:175], v[200:203], v[120:123], v[160:175]
    ds_read_b64_tr_b16 v[192:193], v244 offset:40960
    ds_read_b64_tr_b16 v[194:195], v244 offset:41472
    ds_read_b128 v[128:131], v240 offset:8192
    v_mfma_f32_32x32x16_bf16 v[176:191], v[216:219], v[120:123], v[176:191]
    ds_read_b64_tr_b16 v[208:209], v245 offset:40960
    ds_read_b64_tr_b16 v[210:211], v245 offset:41472
    ds_read_b128 v[132:135], v241 offset:8192
    v_mfma_f32_32x32x16_bf16 v[96:111], v[232:235], v[120:123], v[96:111]
    ds_read_b64_tr_b16 v[224:225], v246 offset:38272
    ds_read_b64_tr_b16 v[226:227], v246 offset:38528
    ds_read_b128 v[136:139], v242 offset:8192
    v_mfma_f32_32x32x16_bf16 v[160:175], v[204:207], v[124:127], v[160:175]
    ds_read_b64_tr_b16 v[196:197], v244 offset:43008
    ds_read_b64_tr_b16 v[198:199], v244 offset:43520
    ds_read_b128 v[140:143], v243 offset:8192
    s_waitcnt lgkmcnt(14)
    v_mfma_f32_32x32x16_bf16 v[176:191], v[220:223], v[124:127], v[176:191]
    ds_read_b64_tr_b16 v[212:213], v245 offset:43008
    ds_read_b64_tr_b16 v[214:215], v245 offset:43520
    s_waitcnt lgkmcnt(14)
    v_mfma_f32_32x32x16_bf16 v[96:111], v[236:239], v[124:127], v[96:111]
    ds_read_b64_tr_b16 v[228:229], v246 offset:39296
    ds_read_b64_tr_b16 v[230:231], v246 offset:39552
    buffer_load_dwordx2 v[8:9], off, s[60:63], 0 sc1
    s_waitcnt lgkmcnt(13)
    v_mfma_f32_32x32x16_bf16 v[160:175], v[192:195], v[128:131], v[160:175]
    ds_read_b64_tr_b16 v[200:201], v244 offset:45056
    ds_read_b64_tr_b16 v[202:203], v244 offset:45568
    s_waitcnt lgkmcnt(13)
    v_mfma_f32_32x32x16_bf16 v[176:191], v[208:211], v[128:131], v[176:191]
    ds_read_b64_tr_b16 v[216:217], v245 offset:45056
    ds_read_b64_tr_b16 v[218:219], v245 offset:45568
    s_waitcnt lgkmcnt(12)
    v_mfma_f32_32x32x16_bf16 v[96:111], v[224:227], v[128:131], v[96:111]
    ds_read_b64_tr_b16 v[232:233], v246 offset:40320
    ds_read_b64_tr_b16 v[234:235], v246 offset:40576
    s_waitcnt lgkmcnt(11)
    v_mfma_f32_32x32x16_bf16 v[160:175], v[196:199], v[132:135], v[160:175]
    ds_read_b64_tr_b16 v[204:205], v244 offset:47104
    ds_read_b64_tr_b16 v[206:207], v244 offset:47616
    ds_read_b32 v7, v26 offset:24
    s_waitcnt lgkmcnt(11)
    v_mfma_f32_32x32x16_bf16 v[176:191], v[212:215], v[132:135], v[176:191]
    ds_read_b64_tr_b16 v[220:221], v245 offset:47104
    ds_read_b64_tr_b16 v[222:223], v245 offset:47616
    s_waitcnt lgkmcnt(11)
    v_mfma_f32_32x32x16_bf16 v[96:111], v[228:231], v[132:135], v[96:111]
    ds_read_b64_tr_b16 v[236:237], v246 offset:41344
    ds_read_b64_tr_b16 v[238:239], v246 offset:41600
    s_waitcnt lgkmcnt(4)
    v_cmp_ne_u32 vcc, 0, v7
    s_nop 0
    s_cbranch_vccnz co_sp14
co_ok15:
    s_waitcnt vmcnt(1)
    v_mfma_f32_32x32x16_bf16 v[160:175], v[200:203], v[136:139], v[160:175]
    ds_read_b64_tr_b16 v[192:193], v244 offset:49152
    ds_read_b64_tr_b16 v[194:195], v244 offset:49664
    ds_read_b128 v[112:115], v240 offset:0
    v_mfma_f32_32x32x16_bf16 v[176:191], v[216:219], v[136:139], v[176:191]
    ds_read_b64_tr_b16 v[208:209], v245 offset:49152
    ds_read_b64_tr_b16 v[210:211], v245 offset:49664
    ds_read_b128 v[116:119], v241 offset:0
    v_mfma_f32_32x32x16_bf16 v[96:111], v[232:235], v[136:139], v[96:111]
    ds_read_b64_tr_b16 v[224:225], v246 offset:42368
    ds_read_b64_tr_b16 v[226:227], v246 offset:42624
    ds_read_b128 v[120:123], v242 offset:0
    v_mfma_f32_32x32x16_bf16 v[160:175], v[204:207], v[140:143], v[160:175]
    ds_read_b64_tr_b16 v[196:197], v244 offset:51200
    ds_read_b64_tr_b16 v[198:199], v244 offset:51712
    ds_read_b128 v[124:127], v243 offset:0
    s_waitcnt lgkmcnt(14)
    v_mfma_f32_32x32x16_bf16 v[176:191], v[220:223], v[140:143], v[176:191]
    ds_read_b64_tr_b16 v[212:213], v245 offset:51200
    ds_read_b64_tr_b16 v[214:215], v245 offset:51712
    s_waitcnt lgkmcnt(14)
    v_mfma_f32_32x32x16_bf16 v[96:111], v[236:239], v[140:143], v[96:111]
    ds_read_b64_tr_b16 v[228:229], v246 offset:43392
    ds_read_b64_tr_b16 v[230:231], v246 offset:43648
    s_waitcnt lgkmcnt(13)
    v_mfma_f32_32x32x16_bf16 v[160:175], v[192:195], v[112:115], v[160:175]
    ds_read_b64_tr_b16 v[200:201], v244 offset:53248
    ds_read_b64_tr_b16 v[202:203], v244 offset:53760
    s_waitcnt lgkmcnt(13)
    v_mfma_f32_32x32x16_bf16 v[176:191], v[208:211], v[112:115], v[176:191]
    ds_read_b64_tr_b16 v[216:217], v245 offset:53248
    ds_read_b64_tr_b16 v[218:219], v245 offset:53760
    s_waitcnt lgkmcnt(12)
    v_mfma_f32_32x32x16_bf16 v[96:111], v[224:227], v[112:115], v[96:111]
    ds_read_b64_tr_b16 v[232:233], v246 offset:44416
    ds_read_b64_tr_b16 v[234:235], v246 offset:44672
    buffer_load_dwordx2 v[12:13], v16, s[48:51], s74 offen sc1
    s_waitcnt lgkmcnt(11)
    v_mfma_f32_32x32x16_bf16 v[160:175], v[196:199], v[116:119], v[160:175]
    ds_read_b64_tr_b16 v[204:205], v244 offset:55296
    ds_read_b64_tr_b16 v[206:207], v244 offset:55808
    s_waitcnt lgkmcnt(10)
    v_mfma_f32_32x32x16_bf16 v[176:191], v[212:215], v[116:119], v[176:191]
    ds_read_b64_tr_b16 v[220:221], v245 offset:55296
    ds_read_b64_tr_b16 v[222:223], v245 offset:55808
    s_waitcnt lgkmcnt(10)
    v_mfma_f32_32x32x16_bf16 v[96:111], v[228:231], v[116:119], v[96:111]
    ds_read_b64_tr_b16 v[236:237], v246 offset:45440
    ds_read_b64_tr_b16 v[238:239], v246 offset:45696
    ds_add_u32 v4, v6 offset:3840
    s_waitcnt lgkmcnt(11)
    v_mfma_f32_32x32x16_bf16 v[160:175], v[200:203], v[120:123], v[160:175]
    s_waitcnt lgkmcnt(9)
    v_mfma_f32_32x32x16_bf16 v[176:191], v[216:219], v[120:123], v[176:191]
    s_waitcnt lgkmcnt(7)
    v_mfma_f32_32x32x16_bf16 v[96:111], v[232:235], v[120:123], v[96:111]
    s_waitcnt lgkmcnt(5)
    v_mfma_f32_32x32x16_bf16 v[160:175], v[204:207], v[124:127], v[160:175]
    s_waitcnt lgkmcnt(3)
    v_mfma_f32_32x32x16_bf16 v[176:191], v[220:223], v[124:127], v[176:191]
    s_waitcnt lgkmcnt(1)
    v_mfma_f32_32x32x16_bf16 v[96:111], v[236:239], v[124:127], v[96:111]
    s_nop 7
    v_cvt_pk_bf16_f32 v192, v160, v161
    v_cvt_pk_bf16_f32 v193, v162, v163
    v_cvt_pk_bf16_f32 v194, v164, v165
    v_cvt_pk_bf16_f32 v195, v166, v167
    buffer_store_dwordx4 v[192:195], v14, s[48:51], s71 offen offset:0 sc1
    v_cvt_pk_bf16_f32 v196, v168, v169
    v_cvt_pk_bf16_f32 v197, v170, v171
    v_cvt_pk_bf16_f32 v198, v172, v173
    v_and_b32 v198, v15, v198
    v_cvt_pk_bf16_f32 v199, v174, v175
    v_and_b32 v199, v15, v199
    buffer_store_dwordx4 v[196:199], v14, s[48:51], s71 offen offset:1024 sc1
    v_cvt_pk_bf16_f32 v200, v176, v177
    v_cvt_pk_bf16_f32 v201, v178, v179
    v_cvt_pk_bf16_f32 v202, v180, v181
    v_cvt_pk_bf16_f32 v203, v182, v183
    buffer_store_dwordx4 v[200:203], v14, s[48:51], s72 offen offset:0 sc1
    v_cvt_pk_bf16_f32 v204, v184, v185
    v_cvt_pk_bf16_f32 v205, v186, v187
    v_cvt_pk_bf16_f32 v206, v188, v189
    v_and_b32 v206, v15, v206
    v_cvt_pk_bf16_f32 v207, v190, v191
    v_and_b32 v207, v15, v207
    buffer_store_dwordx4 v[204:207], v14, s[48:51], s72 offen offset:1024 sc1
    s_branch L_J
L_V:
    s_add_u32 s71, s71, 2048
    s_add_u32 s72, s72, 2048
    v_and_b32 v2, 31, v1
    v_cmp_gt_u32 vcc, 28, v2
    s_nop 1
    v_cndmask_b32 v247, 0, -1, vcc
    v_mov_b32 v3, 0x3f803f80
    v_cmp_eq_u32 vcc, 28, v2
    s_nop 1
    v_cndmask_b32 v248, 0, v3, vcc
    s_mov_b32 s14, 0x98654210
    s_mov_b32 s15, 0x37bfedca
    v_lshlrev_b32 v3, 2, v1
    v_lshrrev_b64 v[10:11], v3, s[14:15]
    v_cmp_gt_u32 vcc, 16, v2
    s_nop 1
    v_cndmask_b32 v3, v10, v1, vcc
    v_and_b32 v14, 8, v3
    v_and_b32 v3, 7, v3
    v_lshl_add_u32 v14, v14, 1, v3
    v_and_or_b32 v14, v1, 32, v14
    v_bfe_u32 v3, v1, 4, 1
    v_lshl_add_u32 v14, v3, 3, v14
    v_lshlrev_b32 v14, 4, v14
    s_waitcnt vmcnt(8)
    ds_read_b128 v[112:115], v240 offset:0
    ds_read_b128 v[116:119], v241 offset:0
    ds_read_b128 v[120:123], v242 offset:0
    ds_read_b128 v[124:127], v243 offset:0
    ds_read_b32 v7, v26 offset:0
    s_mul_i32 s15, s66, 172032
    s_add_u32 s15, s15, s11
    s_lshl_b32 s14, s66, 7
    s_add_u32 s14, s14, s9
    s_add_u32 m0, s13, 16384
    s_nop 0
    buffer_load_dwordx4 v22, s[56:59], s15 offen lds
    s_add_u32 m0, s13, 17408
    s_nop 0
    buffer_load_dwordx4 v23, s[56:59], s15 offen lds
    s_mul_i32 s15, s66, 172032
    s_add_u32 s15, s15, s10
    s_lshl1_add_u32 m0, s47, 123648
    s_nop 0
    buffer_load_dwordx4 v24, s[56:59], s15 offen lds
    s_add_u32 m0, s47, 157704
    s_mov_b64 exec, 1
    buffer_load_dword v25, s[56:59], 0 offen lds
    s_mov_b64 exec, -1
    s_add_u32 m0, s12, 8192
    s_nop 0
    buffer_load_dwordx4 v18, s[52:55], s14 offen lds
    s_add_u32 m0, s12, 9216
    s_nop 0
    buffer_load_dwordx4 v19, s[52:55], s14 offen lds
    s_add_u32 m0, s12, 10240
    s_nop 0
    buffer_load_dwordx4 v20, s[52:55], s14 offen lds
    s_add_u32 m0, s12, 11264
    s_nop 0
    buffer_load_dwordx4 v21, s[52:55], s14 offen lds
    s_waitcnt lgkmcnt(0)
    v_cmp_ne_u32 vcc, 0, v7
    s_nop 0
    s_cbranch_vccnz co_sp16
co_ok17:
    ds_read_b64_tr_b16 v[192:193], v244 offset:0
    ds_read_b64_tr_b16 v[194:195], v244 offset:512
    ds_read_b64_tr_b16 v[208:209], v245 offset:0
    ds_read_b64_tr_b16 v[210:211], v245 offset:512
    ds_read_b64_tr_b16 v[224:225], v246 offset:0
    ds_read_b64_tr_b16 v[226:227], v246 offset:256
    ds_read_b64_tr_b16 v[196:197], v244 offset:2048
    ds_read_b64_tr_b16 v[198:199], v244 offset:2560
    ds_read_b64_tr_b16 v[212:213], v245 offset:2048
    ds_read_b64_tr_b16 v[214:215], v245 offset:2560
    ds_read_b64_tr_b16 v[228:229], v246 offset:1024
    ds_read_b64_tr_b16 v[230:231], v246 offset:1280
    s_waitcnt lgkmcnt(10)
    v_mfma_f32_32x32x16_bf16 v[160:175], v[112:115], v[192:195], 0
    ds_read_b64_tr_b16 v[200:201], v244 offset:4096
    ds_read_b64_tr_b16 v[202:203], v244 offset:4608
    s_waitcnt lgkmcnt(10)
    v_mfma_f32_32x32x16_bf16 v[176:191], v[112:115], v[208:211], 0
    ds_read_b64_tr_b16 v[216:217], v245 offset:4096
    ds_read_b64_tr_b16 v[218:219], v245 offset:4608
    s_waitcnt lgkmcnt(10)
    v_mfma_f32_32x32x16_bf16 v[96:111], v[224:227], v[112:115], 0
    ds_read_b64_tr_b16 v[232:233], v246 offset:2048
    ds_read_b64_tr_b16 v[234:235], v246 offset:2304
    s_waitcnt lgkmcnt(10)
    v_mfma_f32_32x32x16_bf16 v[160:175], v[116:119], v[196:199], v[160:175]
    ds_read_b64_tr_b16 v[204:205], v244 offset:6144
    ds_read_b64_tr_b16 v[206:207], v244 offset:6656
    ds_read_b32 v7, v26 offset:4
    s_waitcnt lgkmcnt(11)
    v_mfma_f32_32x32x16_bf16 v[176:191], v[116:119], v[212:215], v[176:191]
    ds_read_b64_tr_b16 v[220:221], v245 offset:6144
    ds_read_b64_tr_b16 v[222:223], v245 offset:6656
    s_mul_i32 s15, s67, 172032
    s_add_u32 s15, s15, s11
    s_add_u32 m0, s13, 24576
    s_lshl_b32 s14, s67, 7
    buffer_load_dwordx4 v22, s[56:59], s15 offen lds
    s_waitcnt lgkmcnt(11)
    v_mfma_f32_32x32x16_bf16 v[96:111], v[228:231], v[116:119], v[96:111]
    ds_read_b64_tr_b16 v[236:237], v246 offset:3072
    ds_read_b64_tr_b16 v[238:239], v246 offset:3328
    s_add_u32 m0, s13, 25600
    s_add_u32 s14, s14, s9
    buffer_load_dwordx4 v23, s[56:59], s15 offen lds
    s_waitcnt lgkmcnt(4)
    v_cmp_ne_u32 vcc, 0, v7
    s_nop 0
    s_cbranch_vccnz co_sp18
co_ok19:
    s_waitcnt vmcnt(10)
    v_mfma_f32_32x32x16_bf16 v[160:175], v[120:123], v[200:203], v[160:175]
    ds_read_b64_tr_b16 v[192:193], v244 offset:8192
    ds_read_b64_tr_b16 v[194:195], v244 offset:8704
    ds_read_b128 v[128:131], v240 offset:4096
    s_mul_i32 s15, s67, 172032
    s_add_u32 s15, s15, s10
    s_lshl1_add_u32 m0, s47, 127744
    s_nop 0
    buffer_load_dwordx4 v24, s[56:59], s15 offen lds
    v_mfma_f32_32x32x16_bf16 v[176:191], v[120:123], v[216:219], v[176:191]
    ds_read_b64_tr_b16 v[208:209], v245 offset:8192
    ds_read_b64_tr_b16 v[210:211], v245 offset:8704
    ds_read_b128 v[132:135], v241 offset:4096
    s_add_u32 m0, s47, 157708
    s_mov_b64 exec, 1
    buffer_load_dword v25, s[56:59], 0 offen lds
    s_mov_b64 exec, -1
    v_mfma_f32_32x32x16_bf16 v[96:111], v[232:235], v[120:123], v[96:111]
    ds_read_b64_tr_b16 v[224:225], v246 offset:4096
    ds_read_b64_tr_b16 v[226:227], v246 offset:4352
    ds_read_b128 v[136:139], v242 offset:4096
    s_add_u32 m0, s12, 0
    s_nop 0
    buffer_load_dwordx4 v18, s[52:55], s14 offen lds
    v_mfma_f32_32x32x16_bf16 v[160:175], v[124:127], v[204:207], v[160:175]
    ds_read_b64_tr_b16 v[196:197], v244 offset:10240
    ds_read_b64_tr_b16 v[198:199], v244 offset:10752
    ds_read_b128 v[140:143], v243 offset:4096
    s_add_u32 m0, s12, 1024
    s_nop 0
    buffer_load_dwordx4 v19, s[52:55], s14 offen lds
    s_waitcnt lgkmcnt(14)
    v_mfma_f32_32x32x16_bf16 v[176:191], v[124:127], v[220:223], v[176:191]
    ds_read_b64_tr_b16 v[212:213], v245 offset:10240
    ds_read_b64_tr_b16 v[214:215], v245 offset:10752
    s_add_u32 m0, s12, 2048
    s_nop 0
    buffer_load_dwordx4 v20, s[52:55], s14 offen lds
    s_waitcnt lgkmcnt(14)
    v_mfma_f32_32x32x16_bf16 v[96:111], v[236:239], v[124:127], v[96:111]
    ds_read_b64_tr_b16 v[228:229], v246 offset:5120
    ds_read_b64_tr_b16 v[230:231], v246 offset:5376
    s_add_u32 m0, s12, 3072
    s_nop 0
    buffer_load_dwordx4 v21, s[52:55], s14 offen lds
    s_waitcnt lgkmcnt(13)
    v_mfma_f32_32x32x16_bf16 v[160:175], v[128:131], v[192:195], v[160:175]
    ds_read_b64_tr_b16 v[200:201], v244 offset:12288
    ds_read_b64_tr_b16 v[202:203], v244 offset:12800
    s_waitcnt lgkmcnt(13)
    v_mfma_f32_32x32x16_bf16 v[176:191], v[128:131], v[208:211], v[176:191]
    ds_read_b64_tr_b16 v[216:217], v245 offset:12288
    ds_read_b64_tr_b16 v[218:219], v245 offset:12800
    s_waitcnt lgkmcnt(12)
    v_mfma_f32_32x32x16_bf16 v[96:111], v[224:227], v[128:131], v[96:111]
    ds_read_b64_tr_b16 v[232:233], v246 offset:6144
    ds_read_b64_tr_b16 v[234:235], v246 offset:6400
    s_waitcnt lgkmcnt(11)
    v_mfma_f32_32x32x16_bf16 v[160:175], v[132:135], v[196:199], v[160:175]
    ds_read_b64_tr_b16 v[204:205], v244 offset:14336
    ds_read_b64_tr_b16 v[206:207], v244 offset:14848
    ds_read_b32 v7, v26 offset:8
    s_waitcnt lgkmcnt(11)
    v_mfma_f32_32x32x16_bf16 v[176:191], v[132:135], v[212:215], v[176:191]
    ds_read_b64_tr_b16 v[220:221], v245 offset:14336
    ds_read_b64_tr_b16 v[222:223], v245 offset:14848
    s_mul_i32 s15, s68, 172032
    s_add_u32 s15, s15, s11
    s_add_u32 m0, s13, 32768
    s_lshl_b32 s14, s68, 7
    buffer_load_dwordx4 v22, s[56:59], s15 offen lds
    s_waitcnt lgkmcnt(11)
    v_mfma_f32_32x32x16_bf16 v[96:111], v[228:231], v[132:135], v[96:111]
    ds_read_b64_tr_b16 v[236:237], v246 offset:7168
    ds_read_b64_tr_b16 v[238:239], v246 offset:7424
    s_add_u32 m0, s13, 33792
    s_add_u32 s14, s14, s9
    buffer_load_dwordx4 v23, s[56:59], s15 offen lds
    s_waitcnt lgkmcnt(4)
    v_cmp_ne_u32 vcc, 0, v7
    s_nop 0
    s_cbranch_vccnz co_sp20
co_ok21:
    s_waitcnt vmcnt(10)
    v_mfma_f32_32x32x16_bf16 v[160:175], v[136:139], v[200:203], v[160:175]
    ds_read_b64_tr_b16 v[192:193], v244 offset:16384
    ds_read_b64_tr_b16 v[194:195], v244 offset:16896
    ds_read_b128 v[112:115], v240 offset:8192
    s_mul_i32 s15, s68, 172032
    s_add_u32 s15, s15, s10
    s_lshl1_add_u32 m0, s47, 131840
    s_nop 0
    buffer_load_dwordx4 v24, s[56:59], s15 offen lds
    v_mfma_f32_32x32x16_bf16 v[176:191], v[136:139], v[216:219], v[176:191]
    ds_read_b64_tr_b16 v[208:209], v245 offset:16384
    ds_read_b64_tr_b16 v[210:211], v245 offset:16896
    ds_read_b128 v[116:119], v241 offset:8192
    s_add_u32 m0, s47, 157712
    s_mov_b64 exec, 1
    buffer_load_dword v25, s[56:59], 0 offen lds
    s_mov_b64 exec, -1
    v_mfma_f32_32x32x16_bf16 v[96:111], v[232:235], v[136:139], v[96:111]
    ds_read_b64_tr_b16 v[224:225], v246 offset:17152
    ds_read_b64_tr_b16 v[226:227], v246 offset:17408
    ds_read_b128 v[120:123], v242 offset:8192
    s_add_u32 m0, s12, 4096
    s_nop 0
    buffer_load_dwordx4 v18, s[52:55], s14 offen lds
    v_mfma_f32_32x32x16_bf16 v[160:175], v[140:143], v[204:207], v[160:175]
    ds_read_b64_tr_b16 v[196:197], v244 offset:18432
    ds_read_b64_tr_b16 v[198:199], v244 offset:18944
    ds_read_b128 v[124:127], v243 offset:8192
    s_add_u32 m0, s12, 5120
    s_nop 0
    buffer_load_dwordx4 v19, s[52:55], s14 offen lds
    s_waitcnt lgkmcnt(14)
    v_mfma_f32_32x32x16_bf16 v[176:191], v[140:143], v[220:223], v[176:191]
    ds_read_b64_tr_b16 v[212:213], v245 offset:18432
    ds_read_b64_tr_b16 v[214:215], v245 offset:18944
    s_add_u32 m0, s12, 6144
    s_nop 0
    buffer_load_dwordx4 v20, s[52:55], s14 offen lds
    s_waitcnt lgkmcnt(14)
    v_mfma_f32_32x32x16_bf16 v[96:111], v[236:239], v[140:143], v[96:111]
    ds_read_b64_tr_b16 v[228:229], v246 offset:18176
    ds_read_b64_tr_b16 v[230:231], v246 offset:18432
    s_add_u32 m0, s12, 7168
    s_nop 0
    buffer_load_dwordx4 v21, s[52:55], s14 offen lds
    s_waitcnt lgkmcnt(13)
    v_mfma_f32_32x32x16_bf16 v[160:175], v[112:115], v[192:195], v[160:175]
    ds_read_b64_tr_b16 v[200:201], v244 offset:20480
    ds_read_b64_tr_b16 v[202:203], v244 offset:20992
    s_waitcnt lgkmcnt(13)
    v_mfma_f32_32x32x16_bf16 v[176:191], v[112:115], v[208:211], v[176:191]
    ds_read_b64_tr_b16 v[216:217], v245 offset:20480
    ds_read_b64_tr_b16 v[218:219], v245 offset:20992
    s_waitcnt lgkmcnt(12)
    v_mfma_f32_32x32x16_bf16 v[96:111], v[224:227], v[112:115], v[96:111]
    ds_read_b64_tr_b16 v[232:233], v246 offset:19200
    ds_read_b64_tr_b16 v[234:235], v246 offset:19456
    s_waitcnt lgkmcnt(11)
    v_mfma_f32_32x32x16_bf16 v[160:175], v[116:119], v[196:199], v[160:175]
    ds_read_b64_tr_b16 v[204:205], v244 offset:22528
    ds_read_b64_tr_b16 v[206:207], v244 offset:23040
    ds_read_b32 v7, v26 offset:12
    s_waitcnt lgkmcnt(11)
    v_mfma_f32_32x32x16_bf16 v[176:191], v[116:119], v[212:215], v[176:191]
    ds_read_b64_tr_b16 v[220:221], v245 offset:22528
    ds_read_b64_tr_b16 v[222:223], v245 offset:23040
    s_mul_i32 s15, s69, 172032
    s_add_u32 s15, s15, s11
    s_add_u32 m0, s13, 40960
    s_lshl_b32 s14, s69, 7
    buffer_load_dwordx4 v22, s[56:59], s15 offen lds
    s_waitcnt lgkmcnt(11)
    v_mfma_f32_32x32x16_bf16 v[96:111], v[228:231], v[116:119], v[96:111]
    ds_read_b64_tr_b16 v[236:237], v246 offset:20224
    ds_read_b64_tr_b16 v[238:239], v246 offset:20480
    s_add_u32 m0, s13, 41984
    s_add_u32 s14, s14, s9
    buffer_load_dwordx4 v23, s[56:59], s15 offen lds
    s_waitcnt lgkmcnt(4)
    v_cmp_ne_u32 vcc, 0, v7
    s_nop 0
    s_cbranch_vccnz co_sp22
co_ok23:
    s_waitcnt vmcnt(10)
    v_mfma_f32_32x32x16_bf16 v[160:175], v[120:123], v[200:203], v[160:175]
    ds_read_b64_tr_b16 v[192:193], v244 offset:24576
    ds_read_b64_tr_b16 v[194:195], v244 offset:25088
    ds_read_b128 v[128:131], v240 offset:0
    s_mul_i32 s15, s69, 172032
    s_add_u32 s15, s15, s10
    s_lshl1_add_u32 m0, s47, 144768
    s_nop 0
    buffer_load_dwordx4 v24, s[56:59], s15 offen lds
    v_mfma_f32_32x32x16_bf16 v[176:191], v[120:123], v[216:219], v[176:191]
    ds_read_b64_tr_b16 v[208:209], v245 offset:24576
    ds_read_b64_tr_b16 v[210:211], v245 offset:25088
    ds_read_b128 v[132:135], v241 offset:0
    s_add_u32 m0, s47, 157716
    s_mov_b64 exec, 1
    buffer_load_dword v25, s[56:59], 0 offen lds
    s_mov_b64 exec, -1
    v_mfma_f32_32x32x16_bf16 v[96:111], v[232:235], v[120:123], v[96:111]
    ds_read_b64_tr_b16 v[224:225], v246 offset:21248
    ds_read_b64_tr_b16 v[226:227], v246 offset:21504
    ds_read_b128 v[136:139], v242 offset:0
    s_add_u32 m0, s12, 8192
    s_nop 0
    buffer_load_dwordx4 v18, s[52:55], s14 offen lds
    v_mfma_f32_32x32x16_bf16 v[160:175], v[124:127], v[204:207], v[160:175]
    ds_read_b64_tr_b16 v[196:197], v244 offset:26624
    ds_read_b64_tr_b16 v[198:199], v244 offset:27136
    ds_read_b128 v[140:143], v243 offset:0
    s_add_u32 m0, s12, 9216
    s_nop 0
    buffer_load_dwordx4 v19, s[52:55], s14 offen lds
    s_waitcnt lgkmcnt(14)
    v_mfma_f32_32x32x16_bf16 v[176:191], v[124:127], v[220:223], v[176:191]
    ds_read_b64_tr_b16 v[212:213], v245 offset:26624
    ds_read_b64_tr_b16 v[214:215], v245 offset:27136
    s_add_u32 m0, s12, 10240
    s_nop 0
    buffer_load_dwordx4 v20, s[52:55], s14 offen lds
    s_waitcnt lgkmcnt(14)
    v_mfma_f32_32x32x16_bf16 v[96:111], v[236:239], v[124:127], v[96:111]
    ds_read_b64_tr_b16 v[228:229], v246 offset:22272
    ds_read_b64_tr_b16 v[230:231], v246 offset:22528
    s_add_u32 m0, s12, 11264
    s_nop 0
    buffer_load_dwordx4 v21, s[52:55], s14 offen lds
    s_waitcnt lgkmcnt(13)
    v_mfma_f32_32x32x16_bf16 v[160:175], v[128:131], v[192:195], v[160:175]
    ds_read_b64_tr_b16 v[200:201], v244 offset:28672
    ds_read_b64_tr_b16 v[202:203], v244 offset:29184
    s_waitcnt lgkmcnt(13)
    v_mfma_f32_32x32x16_bf16 v[176:191], v[128:131], v[208:211], v[176:191]
    ds_read_b64_tr_b16 v[216:217], v245 offset:28672
    ds_read_b64_tr_b16 v[218:219], v245 offset:29184
    s_waitcnt lgkmcnt(12)
    v_mfma_f32_32x32x16_bf16 v[96:111], v[224:227], v[128:131], v[96:111]
    ds_read_b64_tr_b16 v[232:233], v246 offset:23296
    ds_read_b64_tr_b16 v[234:235], v246 offset:23552
    s_waitcnt lgkmcnt(11)
    v_mfma_f32_32x32x16_bf16 v[160:175], v[132:135], v[196:199], v[160:175]
    ds_read_b64_tr_b16 v[204:205], v244 offset:30720
    ds_read_b64_tr_b16 v[206:207], v244 offset:31232
    ds_read_b32 v7, v26 offset:16
    s_waitcnt lgkmcnt(11)
    v_mfma_f32_32x32x16_bf16 v[176:191], v[132:135], v[212:215], v[176:191]
    ds_read_b64_tr_b16 v[220:221], v245 offset:30720
    ds_read_b64_tr_b16 v[222:223], v245 offset:31232
    s_mul_i32 s15, s70, 172032
    s_add_u32 s15, s15, s11
    s_add_u32 m0, s13, 49152
    s_lshl_b32 s14, s70, 7
    buffer_load_dwordx4 v22, s[56:59], s15 offen lds
    s_waitcnt lgkmcnt(11)
    v_mfma_f32_32x32x16_bf16 v[96:111], v[228:231], v[132:135], v[96:111]
    ds_read_b64_tr_b16 v[236:237], v246 offset:24320
    ds_read_b64_tr_b16 v[238:239], v246 offset:24576
    s_add_u32 m0, s13, 50176
    s_add_u32 s14, s14, s9
    buffer_load_dwordx4 v23, s[56:59], s15 offen lds
    s_waitcnt lgkmcnt(4)
    v_cmp_ne_u32 vcc, 0, v7
    s_nop 0
    s_cbranch_vccnz co_sp24
co_ok25:
    s_waitcnt vmcnt(10)
    v_mfma_f32_32x32x16_bf16 v[160:175], v[136:139], v[200:203], v[160:175]
    ds_read_b64_tr_b16 v[192:193], v244 offset:32768
    ds_read_b64_tr_b16 v[194:195], v244 offset:33280
    ds_read_b128 v[112:115], v240 offset:4096
    s_mul_i32 s15, s70, 172032
    s_add_u32 s15, s15, s10
    s_lshl1_add_u32 m0, s47, 148864
    s_nop 0
    buffer_load_dwordx4 v24, s[56:59], s15 offen lds
    v_mfma_f32_32x32x16_bf16 v[176:191], v[136:139], v[216:219], v[176:191]
    ds_read_b64_tr_b16 v[208:209], v245 offset:32768
    ds_read_b64_tr_b16 v[210:211], v245 offset:33280
    ds_read_b128 v[116:119], v241 offset:4096
    s_add_u32 m0, s47, 157720
    s_mov_b64 exec, 1
    buffer_load_dword v25, s[56:59], 0 offen lds
    s_mov_b64 exec, -1
    v_mfma_f32_32x32x16_bf16 v[96:111], v[232:235], v[136:139], v[96:111]
    ds_read_b64_tr_b16 v[224:225], v246 offset:25344
    ds_read_b64_tr_b16 v[226:227], v246 offset:25600
    ds_read_b128 v[120:123], v242 offset:4096
    s_add_u32 m0, s12, 0
    s_nop 0
    buffer_load_dwordx4 v18, s[52:55], s14 offen lds
    v_mfma_f32_32x32x16_bf16 v[160:175], v[140:143], v[204:207], v[160:175]
    ds_read_b64_tr_b16 v[196:197], v244 offset:34816
    ds_read_b64_tr_b16 v[198:199], v244 offset:35328
    ds_read_b128 v[124:127], v243 offset:4096
    s_add_u32 m0, s12, 1024
    s_nop 0
    buffer_load_dwordx4 v19, s[52:55], s14 offen lds
    s_waitcnt lgkmcnt(14)
    v_mfma_f32_32x32x16_bf16 v[176:191], v[140:143], v[220:223], v[176:191]
    ds_read_b64_tr_b16 v[212:213], v245 offset:34816
    ds_read_b64_tr_b16 v[214:215], v245 offset:35328
    s_add_u32 m0, s12, 2048
    s_nop 0
    buffer_load_dwordx4 v20, s[52:55], s14 offen lds
    s_waitcnt lgkmcnt(14)
    v_mfma_f32_32x32x16_bf16 v[96:111], v[236:239], v[140:143], v[96:111]
    ds_read_b64_tr_b16 v[228:229], v246 offset:26368
    ds_read_b64_tr_b16 v[230:231], v246 offset:26624
    s_add_u32 m0, s12, 3072
    s_nop 0
    buffer_load_dwordx4 v21, s[52:55], s14 offen lds
    s_waitcnt lgkmcnt(13)
    v_mfma_f32_32x32x16_bf16 v[160:175], v[112:115], v[192:195], v[160:175]
    ds_read_b64_tr_b16 v[200:201], v244 offset:36864
    ds_read_b64_tr_b16 v[202:203], v244 offset:37376
    s_waitcnt lgkmcnt(13)
    v_mfma_f32_32x32x16_bf16 v[176:191], v[112:115], v[208:211], v[176:191]
    ds_read_b64_tr_b16 v[216:217], v245 offset:36864
    ds_read_b64_tr_b16 v[218:219], v245 offset:37376
    s_waitcnt lgkmcnt(12)
    v_mfma_f32_32x32x16_bf16 v[96:111], v[224:227], v[112:115], v[96:111]
    ds_read_b64_tr_b16 v[232:233], v246 offset:27392
    ds_read_b64_tr_b16 v[234:235], v246 offset:27648
    s_waitcnt lgkmcnt(11)
    v_mfma_f32_32x32x16_bf16 v[160:175], v[116:119], v[196:199], v[160:175]
    ds_read_b64_tr_b16 v[204:205], v244 offset:38912
    ds_read_b64_tr_b16 v[206:207], v244 offset:39424
    ds_read_b32 v7, v26 offset:20
    s_waitcnt lgkmcnt(11)
    v_mfma_f32_32x32x16_bf16 v[176:191], v[116:119], v[212:215], v[176:191]
    ds_read_b64_tr_b16 v[220:221], v245 offset:38912
    ds_read_b64_tr_b16 v[222:223], v245 offset:39424
    s_waitcnt lgkmcnt(11)
    v_mfma_f32_32x32x16_bf16 v[96:111], v[228:231], v[116:119], v[96:111]
    ds_read_b64_tr_b16 v[236:237], v246 offset:28416
    ds_read_b64_tr_b16 v[238:239], v246 offset:28672
    s_waitcnt lgkmcnt(4)
    v_cmp_ne_u32 vcc, 0, v7
    s_nop 0
    s_cbranch_vccnz co_sp26
co_ok27:
    s_waitcnt vmcnt(8)
    v_mfma_f32_32x32x16_bf16 v[160:175], v[120:123], v[200:203], v[160:175]
    ds_read_b64_tr_b16 v[192:193], v244 offset:40960
    ds_read_b64_tr_b16 v[194:195], v244 offset:41472
    ds_read_b128 v[128:131], v240 offset:8192
    v_mfma_f32_32x32x16_bf16 v[176:191], v[120:123], v[216:219], v[176:191]
    ds_read_b64_tr_b16 v[208:209], v245 offset:40960
    ds_read_b64_tr_b16 v[210:211], v245 offset:41472
    ds_read_b128 v[132:135], v241 offset:8192
    v_mfma_f32_32x32x16_bf16 v[96:111], v[232:235], v[120:123], v[96:111]
    ds_read_b64_tr_b16 v[224:225], v246 offset:38272
    ds_read_b64_tr_b16 v[226:227], v246 offset:38528
    ds_read_b128 v[136:139], v242 offset:8192
    v_mfma_f32_32x32x16_bf16 v[160:175], v[124:127], v[204:207], v[160:175]
    ds_read_b64_tr_b16 v[196:197], v244 offset:43008
    ds_read_b64_tr_b16 v[198:199], v244 offset:43520
    ds_read_b128 v[140:143], v243 offset:8192
    s_waitcnt lgkmcnt(14)
    v_mfma_f32_32x32x16_bf16 v[176:191], v[124:127], v[220:223], v[176:191]
    ds_read_b64_tr_b16 v[212:213], v245 offset:43008
    ds_read_b64_tr_b16 v[214:215], v245 offset:43520
    s_waitcnt lgkmcnt(14)
    v_mfma_f32_32x32x16_bf16 v[96:111], v[236:239], v[124:127], v[96:111]
    ds_read_b64_tr_b16 v[228:229], v246 offset:39296
    ds_read_b64_tr_b16 v[230:231], v246 offset:39552
    buffer_load_dwordx2 v[8:9], off, s[60:63], 0 sc1
    s_waitcnt lgkmcnt(13)
    v_mfma_f32_32x32x16_bf16 v[160:175], v[128:131], v[192:195], v[160:175]
    ds_read_b64_tr_b16 v[200:201], v244 offset:45056
    ds_read_b64_tr_b16 v[202:203], v244 offset:45568
    s_waitcnt lgkmcnt(13)
    v_mfma_f32_32x32x16_bf16 v[176:191], v[128:131], v[208:211], v[176:191]
    ds_read_b64_tr_b16 v[216:217], v245 offset:45056
    ds_read_b64_tr_b16 v[218:219], v245 offset:45568
    s_waitcnt lgkmcnt(12)
    v_mfma_f32_32x32x16_bf16 v[96:111], v[224:227], v[128:131], v[96:111]
    ds_read_b64_tr_b16 v[232:233], v246 offset:40320
    ds_read_b64_tr_b16 v[234:235], v246 offset:40576
    s_waitcnt lgkmcnt(11)
    v_mfma_f32_32x32x16_bf16 v[160:175], v[132:135], v[196:199], v[160:175]
    ds_read_b64_tr_b16 v[204:205], v244 offset:47104
    ds_read_b64_tr_b16 v[206:207], v244 offset:47616
    ds_read_b32 v7, v26 offset:24
    s_waitcnt lgkmcnt(11)
    v_mfma_f32_32x32x16_bf16 v[176:191], v[132:135], v[212:215], v[176:191]
    ds_read_b64_tr_b16 v[220:221], v245 offset:47104
    ds_read_b64_tr_b16 v[222:223], v245 offset:47616
    s_waitcnt lgkmcnt(11)
    v_mfma_f32_32x32x16_bf16 v[96:111], v[228:231], v[132:135], v[96:111]
    ds_read_b64_tr_b16 v[236:237], v246 offset:41344
    ds_read_b64_tr_b16 v[238:239], v246 offset:41600
    s_waitcnt lgkmcnt(4)
    v_cmp_ne_u32 vcc, 0, v7
    s_nop 0
    s_cbranch_vccnz co_sp28
co_ok29:
    s_waitcnt vmcnt(1)
    v_mfma_f32_32x32x16_bf16 v[160:175], v[136:139], v[200:203], v[160:175]
    ds_read_b64_tr_b16 v[192:193], v244 offset:49152
    ds_read_b64_tr_b16 v[194:195], v244 offset:49664
    ds_read_b128 v[112:115], v240 offset:0
    v_mfma_f32_32x32x16_bf16 v[176:191], v[136:139], v[216:219], v[176:191]
    ds_read_b64_tr_b16 v[208:209], v245 offset:49152
    ds_read_b64_tr_b16 v[210:211], v245 offset:49664
    ds_read_b128 v[116:119], v241 offset:0
    v_mfma_f32_32x32x16_bf16 v[96:111], v[232:235], v[136:139], v[96:111]
    ds_read_b64_tr_b16 v[224:225], v246 offset:42368
    ds_read_b64_tr_b16 v[226:227], v246 offset:42624
    ds_read_b128 v[120:123], v242 offset:0
    v_mfma_f32_32x32x16_bf16 v[160:175], v[140:143], v[204:207], v[160:175]
    ds_read_b64_tr_b16 v[196:197], v244 offset:51200
    ds_read_b64_tr_b16 v[198:199], v244 offset:51712
    ds_read_b128 v[124:127], v243 offset:0
    s_waitcnt lgkmcnt(14)
    v_mfma_f32_32x32x16_bf16 v[176:191], v[140:143], v[220:223], v[176:191]
    ds_read_b64_tr_b16 v[212:213], v245 offset:51200
    ds_read_b64_tr_b16 v[214:215], v245 offset:51712
    s_waitcnt lgkmcnt(14)
    v_mfma_f32_32x32x16_bf16 v[96:111], v[236:239], v[140:143], v[96:111]
    ds_read_b64_tr_b16 v[228:229], v246 offset:43392
    ds_read_b64_tr_b16 v[230:231], v246 offset:43648
    s_waitcnt lgkmcnt(13)
    v_mfma_f32_32x32x16_bf16 v[160:175], v[112:115], v[192:195], v[160:175]
    ds_read_b64_tr_b16 v[200:201], v244 offset:53248
    ds_read_b64_tr_b16 v[202:203], v244 offset:53760
    s_waitcnt lgkmcnt(13)
    v_mfma_f32_32x32x16_bf16 v[176:191], v[112:115], v[208:211], v[176:191]
    ds_read_b64_tr_b16 v[216:217], v245 offset:53248
    ds_read_b64_tr_b16 v[218:219], v245 offset:53760
    s_waitcnt lgkmcnt(12)
    v_mfma_f32_32x32x16_bf16 v[96:111], v[224:227], v[112:115], v[96:111]
    ds_read_b64_tr_b16 v[232:233], v246 offset:44416
    ds_read_b64_tr_b16 v[234:235], v246 offset:44672
    buffer_load_dwordx2 v[12:13], v16, s[48:51], s74 offen sc1
    s_waitcnt lgkmcnt(11)
    v_mfma_f32_32x32x16_bf16 v[160:175], v[116:119], v[196:199], v[160:175]
    ds_read_b64_tr_b16 v[204:205], v244 offset:55296
    ds_read_b64_tr_b16 v[206:207], v244 offset:55808
    s_waitcnt lgkmcnt(10)
    v_mfma_f32_32x32x16_bf16 v[176:191], v[116:119], v[212:215], v[176:191]
    ds_read_b64_tr_b16 v[220:221], v245 offset:55296
    ds_read_b64_tr_b16 v[222:223], v245 offset:55808
    s_waitcnt lgkmcnt(10)
    v_mfma_f32_32x32x16_bf16 v[96:111], v[228:231], v[116:119], v[96:111]
    ds_read_b64_tr_b16 v[236:237], v246 offset:45440
    ds_read_b64_tr_b16 v[238:239], v246 offset:45696
    ds_add_u32 v4, v6 offset:3840
    s_waitcnt lgkmcnt(11)
    v_mfma_f32_32x32x16_bf16 v[160:175], v[120:123], v[200:203], v[160:175]
    s_waitcnt lgkmcnt(9)
    v_mfma_f32_32x32x16_bf16 v[176:191], v[120:123], v[216:219], v[176:191]
    s_waitcnt lgkmcnt(7)
    v_mfma_f32_32x32x16_bf16 v[96:111], v[232:235], v[120:123], v[96:111]
    s_waitcnt lgkmcnt(5)
    v_mfma_f32_32x32x16_bf16 v[160:175], v[124:127], v[204:207], v[160:175]
    s_waitcnt lgkmcnt(3)
    v_mfma_f32_32x32x16_bf16 v[176:191], v[124:127], v[220:223], v[176:191]
    s_waitcnt lgkmcnt(1)
    v_mfma_f32_32x32x16_bf16 v[96:111], v[236:239], v[124:127], v[96:111]
    s_nop 7
    v_cvt_pk_bf16_f32 v192, v160, v161
    v_and_or_b32 v192, v192, v247, v248
    v_cvt_pk_bf16_f32 v193, v162, v163
    v_and_or_b32 v193, v193, v247, v248
    v_cvt_pk_bf16_f32 v194, v164, v165
    v_and_or_b32 v194, v194, v247, v248
    v_cvt_pk_bf16_f32 v195, v166, v167
    v_and_or_b32 v195, v195, v247, v248
    buffer_store_dwordx4 v[192:195], v14, s[48:51], s71 offen offset:0 sc1
    v_cvt_pk_bf16_f32 v196, v168, v169
    v_and_or_b32 v196, v196, v247, v248
    v_cvt_pk_bf16_f32 v197, v170, v171
    v_and_or_b32 v197, v197, v247, v248
    v_cvt_pk_bf16_f32 v198, v172, v173
    v_and_or_b32 v198, v198, v247, v248
    v_cvt_pk_bf16_f32 v199, v174, v175
    v_and_or_b32 v199, v199, v247, v248
    buffer_store_dwordx4 v[196:199], v14, s[48:51], s71 offen offset:1024 sc1
    v_cvt_pk_bf16_f32 v200, v176, v177
    v_and_or_b32 v200, v200, v247, v248
    v_cvt_pk_bf16_f32 v201, v178, v179
    v_and_or_b32 v201, v201, v247, v248
    v_cvt_pk_bf16_f32 v202, v180, v181
    v_and_or_b32 v202, v202, v247, v248
    v_cvt_pk_bf16_f32 v203, v182, v183
    v_and_or_b32 v203, v203, v247, v248
    buffer_store_dwordx4 v[200:203], v14, s[48:51], s72 offen offset:0 sc1
    v_cvt_pk_bf16_f32 v204, v184, v185
    v_and_or_b32 v204, v204, v247, v248
    v_cvt_pk_bf16_f32 v205, v186, v187
    v_and_or_b32 v205, v205, v247, v248
    v_cvt_pk_bf16_f32 v206, v188, v189
    v_and_or_b32 v206, v206, v247, v248
    v_cvt_pk_bf16_f32 v207, v190, v191
    v_and_or_b32 v207, v207, v247, v248
    buffer_store_dwordx4 v[204:207], v14, s[48:51], s72 offen offset:1024 sc1
L_J:
    s_waitcnt vmcnt(5)
    v_cmp_eq_u32 vcc, 0, v8
    s_nop 0
    s_cbranch_vccnz co_sp30
co_ok31:
    s_waitcnt vmcnt(4)
    v_cmp_eq_u64 vcc, v[12:13], v[8:9]
    s_nop 0
    s_and_b32 s16, vcc_lo, vcc_hi
    s_bcnt1_i32_b32 s18, s16
    s_cmp_ge_u32 s18, 8
    s_cbranch_scc0 L_t1
    s_and_b32 s18, s16, s17
    s_ff1_i32_b32 s18, s18
    s_lshl_b32 s9, s18, 14
    s_and_b32 s9, s9, 0x3c000
    s_bitset0_b32 s17, s18
    buffer_load_dwordx4 v[32:35], v17, s[48:51], s9 offen offset:0 sc1
    buffer_load_dwordx4 v[36:39], v17, s[48:51], s9 offen offset:1024 sc1
    buffer_load_dwordx4 v[40:43], v17, s[48:51], s9 offen offset:2048 sc1
    buffer_load_dwordx4 v[44:47], v17, s[48:51], s9 offen offset:3072 sc1
    s_and_b32 s18, s16, s17
    s_ff1_i32_b32 s18, s18
    s_lshl_b32 s9, s18, 14
    s_and_b32 s9, s9, 0x3c000
    s_bitset0_b32 s17, s18
    buffer_load_dwordx4 v[48:51], v17, s[48:51], s9 offen offset:0 sc1
    buffer_load_dwordx4 v[52:55], v17, s[48:51], s9 offen offset:1024 sc1
    buffer_load_dwordx4 v[56:59], v17, s[48:51], s9 offen offset:2048 sc1
    buffer_load_dwordx4 v[60:63], v17, s[48:51], s9 offen offset:3072 sc1
    s_mov_b32 s19, 1
L_t1:
    v_mov_b32 v27, 0xdddddddd
    v_add_u32 v2, s13, v5
    s_mov_b32 s14, 0x3e8b97f6
    v_mul_f32 v96, s14, v96
    v_mul_f32 v97, s14, v97
    v_mul_f32 v98, s14, v98
    v_mul_f32 v99, s14, v99
    v_mul_f32 v100, s14, v100
    v_mul_f32 v101, s14, v101
    v_mul_f32 v102, s14, v102
    v_mul_f32 v103, s14, v103
    v_mul_f32 v104, s14, v104
    v_mul_f32 v105, s14, v105
    v_mul_f32 v106, s14, v106
    v_mul_f32 v107, s14, v107
    v_mul_f32 v108, s14, v108
    v_mul_f32 v109, s14, v109
    v_mul_f32 v110, s14, v110
    v_mul_f32 v111, s14, v111
    v_cvt_pk_bf16_f32 v224, v96, v97
    v_cvt_pk_bf16_f32 v225, v98, v99
    v_cvt_pk_bf16_f32 v226, v100, v101
    v_cvt_pk_bf16_f32 v227, v102, v103
    v_cvt_pk_bf16_f32 v228, v104, v105
    v_cvt_pk_bf16_f32 v229, v106, v107
    v_cvt_pk_bf16_f32 v230, v108, v109
    v_cvt_pk_bf16_f32 v231, v110, v111
    v_and_b32 v230, v15, v230
    v_and_b32 v231, v15, v231
    ds_write_b128 v2, v[224:227] offset:0
    ds_write_b128 v2, v[228:231] offset:1024
    ds_add_u32 v4, v6 offset:2048
    ds_read_b32 v7, v4 offset:2048
    buffer_load_dwordx2 v[10:11], v16, s[48:51], s74 offen sc1
    v_mov_b32 v152, 0
    v_mov_b32 v153, 0
    v_mov_b32 v154, 0
    v_mov_b32 v155, 0
    v_mov_b32 v156, 0
    v_mov_b32 v157, 0
    v_mov_b32 v158, 0
    v_mov_b32 v159, 0
    v_mov_b32 v92, 0
    v_mov_b32 v93, 0
    v_mov_b32 v94, 0
    v_mov_b32 v95, 0
    s_nop 1
    v_mfma_f32_32x32x16_bf16 v[160:175], v[92:95], v[92:95], 0
    v_mfma_f32_32x32x16_bf16 v[176:191], v[92:95], v[92:95], 0
    v_mfma_f32_32x32x16_bf16 v[192:207], v[92:95], v[92:95], 0
    v_mfma_f32_32x32x16_bf16 v[208:223], v[92:95], v[92:95], 0
    buffer_load_dwordx2 v[12:13], v16, s[48:51], s74 offen sc1
    s_waitcnt vmcnt(2)
    s_mov_b64 exec, 1
    buffer_store_dwordx2 v[8:9], off, s[48:51], s73
    s_bitset1_b32 s73, 15
    s_mov_b64 exec, -1
    s_cmp_lg_u32 s19, 0
    s_cbranch_scc1 L_t2
    buffer_load_dwordx2 v[112:113], v16, s[48:51], s74 offen sc1
    s_waitcnt vmcnt(3)
    v_cmp_eq_u64 vcc, v[10:11], v[8:9]
    s_nop 0
    s_and_b32 s16, vcc_lo, vcc_hi
    s_bcnt1_i32_b32 s18, s16
    s_cmp_ge_u32 s18, 8
    s_cbranch_scc1 co_ok32
    s_waitcnt vmcnt(2)
    v_cmp_eq_u64 vcc, v[12:13], v[8:9]
    s_nop 0
    s_and_b32 s16, vcc_lo, vcc_hi
    s_bcnt1_i32_b32 s18, s16
    s_cmp_ge_u32 s18, 8
    s_cbranch_scc1 co_ok32
    s_waitcnt vmcnt(0)
    v_cmp_eq_u64 vcc, v[112:113], v[8:9]
    s_nop 0
    s_and_b32 s16, vcc_lo, vcc_hi
    s_bcnt1_i32_b32 s18, s16
    s_cmp_ge_u32 s18, 8
    s_cbranch_scc0 co_sq33
co_ok32:
    s_and_b32 s18, s16, s17
    s_ff1_i32_b32 s18, s18
    s_lshl_b32 s9, s18, 14
    s_and_b32 s9, s9, 0x3c000
    s_bitset0_b32 s17, s18
    buffer_load_dwordx4 v[32:35], v17, s[48:51], s9 offen offset:0 sc1
    buffer_load_dwordx4 v[36:39], v17, s[48:51], s9 offen offset:1024 sc1
    buffer_load_dwordx4 v[40:43], v17, s[48:51], s9 offen offset:2048 sc1
    buffer_load_dwordx4 v[44:47], v17, s[48:51], s9 offen offset:3072 sc1
    s_and_b32 s18, s16, s17
    s_ff1_i32_b32 s18, s18
    s_lshl_b32 s9, s18, 14
    s_and_b32 s9, s9, 0x3c000
    s_bitset0_b32 s17, s18
    buffer_load_dwordx4 v[48:51], v17, s[48:51], s9 offen offset:0 sc1
    buffer_load_dwordx4 v[52:55], v17, s[48:51], s9 offen offset:1024 sc1
    buffer_load_dwordx4 v[56:59], v17, s[48:51], s9 offen offset:2048 sc1
    buffer_load_dwordx4 v[60:63], v17, s[48:51], s9 offen offset:3072 sc1
L_t2:
    buffer_load_dwordx2 v[12:13], v16, s[48:51], s74 offen sc1
    s_and_b32 s18, s16, s17
    s_ff1_i32_b32 s18, s18
    s_lshl_b32 s9, s18, 14
    s_and_b32 s9, s9, 0x3c000
    s_bitset0_b32 s17, s18
    buffer_load_dwordx4 v[64:67], v17, s[48:51], s9 offen offset:0 sc1
    buffer_load_dwordx4 v[68:71], v17, s[48:51], s9 offen offset:1024 sc1
    buffer_load_dwordx4 v[72:75], v17, s[48:51], s9 offen offset:2048 sc1
    buffer_load_dwordx4 v[76:79], v17, s[48:51], s9 offen offset:3072 sc1
    s_waitcnt lgkmcnt(0)
    v_readfirstlane_b32 s47, v7
    s_nop 0
    s_cmp_lt_u32 s47, 4
    s_cbranch_scc1 co_sp37
co_ok38:
    s_add_u32 s14, s3, 1
    s_and_b32 s14, s14, 3
    s_lshl_b32 s14, s14, 11
    v_add_u32 v2, s14, v5
    ds_read_b128 v[232:235], v2 offset:0
    ds_read_b128 v[236:239], v2 offset:1024
    s_add_u32 s14, s3, 2
    s_and_b32 s14, s14, 3
    s_lshl_b32 s14, s14, 11
    v_add_u32 v2, s14, v5
    ds_read_b128 v[240:243], v2 offset:0
    ds_read_b128 v[244:247], v2 offset:1024
    s_add_u32 s14, s3, 3
    s_and_b32 s14, s14, 3
    s_lshl_b32 s14, s14, 11
    v_add_u32 v2, s14, v5
    ds_read_b128 v[248:251], v2 offset:0
    ds_read_b128 v[252:255], v2 offset:1024
    ds_add_u32 v4, v6 offset:2048
    s_and_b32 s18, s16, s17
    s_cbranch_scc0 co_sq40
co_ok39:
    s_ff1_i32_b32 s18, s18
    s_mov_b64 exec, 1
    buffer_store_dwordx2 v[8:9], off, s[48:51], s73 sc1
    s_mov_b64 exec, -1
    s_waitcnt vmcnt(13)
    v_mfma_f32_32x32x16_bf16 v[96:111], v[32:35], v[224:227], 0
    s_waitcnt vmcnt(12)
    v_mfma_f32_32x32x16_bf16 v[96:111], v[36:39], v[228:231], v[96:111]
    s_waitcnt vmcnt(10)
    s_waitcnt lgkmcnt(0)
    s_mov_b32 s12, 3
    s_nop 8
    s_nop 0
    s_branch L_lp0
L_loop:
    v_mfma_f32_32x32x16_bf16 v[112:127], v[48:51], v[240:243], 0
    s_lshl_b32 s9, s18, 14
    v_exp_f32 v96, v96
    v_exp_f32 v97, v97
    v_exp_f32 v98, v98
    v_exp_f32 v99, v99
    v_mfma_f32_32x32x16_bf16 v[112:127], v[52:55], v[244:247], v[112:127]
    s_and_b32 s9, s9, 0x3c000
    v_exp_f32 v100, v100
    v_exp_f32 v101, v101
    v_exp_f32 v102, v102
    v_exp_f32 v103, v103
    v_smfmac_f32_32x32x32_bf16 v[208:223], v[44:47], v[152:159], v27
    buffer_load_dwordx4 v[32:35], v17, s[48:51], s9 offen offset:0 sc1
    s_bitset0_b32 s17, s18
    v_exp_f32 v104, v104
    v_exp_f32 v105, v105
    v_exp_f32 v106, v106
    v_exp_f32_e64 v107, v107
    v_smfmac_f32_32x32x32_bf16 v[176:191], v[56:59], v[96:103], v27
    v_exp_f32 v108, v108
    v_exp_f32 v109, v109
    v_exp_f32 v110, v110
    v_exp_f32 v111, v111
    v_mfma_f32_32x32x16_bf16 v[128:143], v[48:51], v[248:251], 0
    v_exp_f32 v112, v112
    v_exp_f32 v113, v113
    v_exp_f32 v114, v114
    v_exp_f32 v115, v115
    v_mfma_f32_32x32x16_bf16 v[128:143], v[52:55], v[252:255], v[128:143]
    v_exp_f32 v116, v116
    v_exp_f32 v117, v117
    v_exp_f32 v118, v118
    v_exp_f32 v119, v119
    v_smfmac_f32_32x32x32_bf16 v[176:191], v[60:63], v[104:111], v27
    buffer_load_dwordx4 v[36:39], v17, s[48:51], s9 offen offset:1024 sc1
    v_exp_f32 v120, v120
    v_exp_f32 v121, v121
    v_exp_f32 v122, v122
    v_exp_f32 v123, v123
    v_smfmac_f32_32x32x32_bf16 v[192:207], v[56:59], v[112:119], v27
    v_exp_f32 v124, v124
    v_exp_f32 v125, v125
    v_exp_f32 v126, v126
    v_exp_f32 v127, v127
    v_mfma_f32_32x32x16_bf16 v[144:159], v[48:51], v[224:227], 0
    v_exp_f32 v128, v128
    v_exp_f32 v129, v129
    v_exp_f32 v130, v130
    v_exp_f32 v131, v131
    v_mfma_f32_32x32x16_bf16 v[144:159], v[52:55], v[228:231], v[144:159]
    v_exp_f32 v132, v132
    v_exp_f32 v133, v133
    v_exp_f32 v134, v134
    v_exp_f32 v135, v135
    v_smfmac_f32_32x32x32_bf16 v[192:207], v[60:63], v[120:127], v27
    buffer_load_dwordx4 v[40:43], v17, s[48:51], s9 offen offset:2048 sc1
    v_exp_f32 v136, v136
    v_exp_f32 v137, v137
    v_exp_f32 v138, v138
    v_exp_f32 v139, v139
    v_smfmac_f32_32x32x32_bf16 v[208:223], v[56:59], v[128:135], v27
    s_waitcnt vmcnt(7)
    v_exp_f32 v140, v140
    v_exp_f32 v141, v141
    v_exp_f32 v142, v142
    v_exp_f32_e64 v143, v143
    v_mfma_f32_32x32x16_bf16 v[96:111], v[64:67], v[224:227], 0
    v_exp_f32 v144, v144
    v_exp_f32 v145, v145
    v_exp_f32 v146, v146
    v_exp_f32 v147, v147
    v_mfma_f32_32x32x16_bf16 v[96:111], v[68:71], v[228:231], v[96:111]
    s_and_b32 s18, s16, s17
    v_exp_f32 v148, v148
    v_exp_f32 v149, v149
    v_exp_f32 v150, v150
    v_exp_f32_e64 v151, v151
    v_smfmac_f32_32x32x32_bf16 v[208:223], v[60:63], v[136:143], v27
    buffer_load_dwordx4 v[44:47], v17, s[48:51], s9 offen offset:3072 sc1
    s_cbranch_scc0 co_sq46
co_ok45:
    v_exp_f32 v152, v152
    v_exp_f32 v153, v153
    v_exp_f32 v154, v154
    v_exp_f32_e64 v155, v155
    v_smfmac_f32_32x32x32_bf16 v[160:175], v[56:59], v[144:151], v27
    s_ff1_i32_b32 s18, s18
    v_exp_f32 v156, v156
    v_exp_f32 v157, v157
    v_exp_f32 v158, v158
    v_exp_f32_e64 v159, v159
    v_mfma_f32_32x32x16_bf16 v[112:127], v[64:67], v[232:235], 0
    s_lshl_b32 s9, s18, 14
    v_exp_f32 v96, v96
    v_exp_f32 v97, v97
    v_exp_f32 v98, v98
    v_exp_f32_e64 v99, v99
    v_mfma_f32_32x32x16_bf16 v[112:127], v[68:71], v[236:239], v[112:127]
    s_and_b32 s9, s9, 0x3c000
    v_exp_f32 v100, v100
    v_exp_f32 v101, v101
    v_exp_f32 v102, v102
    v_exp_f32 v103, v103
    v_smfmac_f32_32x32x32_bf16 v[160:175], v[60:63], v[152:159], v27
    buffer_load_dwordx4 v[48:51], v17, s[48:51], s9 offen offset:0 sc1
    s_bitset0_b32 s17, s18
    v_exp_f32 v104, v104
    v_exp_f32 v105, v105
    v_exp_f32 v106, v106
    v_exp_f32_e64 v107, v107
    v_smfmac_f32_32x32x32_bf16 v[160:175], v[72:75], v[96:103], v27
    v_exp_f32 v108, v108
    v_exp_f32 v109, v109
    v_exp_f32 v110, v110
    v_exp_f32 v111, v111
    v_mfma_f32_32x32x16_bf16 v[128:143], v[64:67], v[240:243], 0
    v_exp_f32 v112, v112
    v_exp_f32 v113, v113
    v_exp_f32 v114, v114
    v_exp_f32 v115, v115
    v_mfma_f32_32x32x16_bf16 v[128:143], v[68:71], v[244:247], v[128:143]
    v_exp_f32 v116, v116
    v_exp_f32 v117, v117
    v_exp_f32 v118, v118
    v_exp_f32 v119, v119
    v_smfmac_f32_32x32x32_bf16 v[160:175], v[76:79], v[104:111], v27
    buffer_load_dwordx4 v[52:55], v17, s[48:51], s9 offen offset:1024 sc1
    v_exp_f32 v120, v120
    v_exp_f32 v121, v121
    v_exp_f32 v122, v122
    v_exp_f32 v123, v123
    v_smfmac_f32_32x32x32_bf16 v[176:191], v[72:75], v[112:119], v27
    v_exp_f32 v124, v124
    v_exp_f32 v125, v125
    v_exp_f32 v126, v126
    v_exp_f32 v127, v127
    v_mfma_f32_32x32x16_bf16 v[144:159], v[64:67], v[248:251], 0
    v_exp_f32 v128, v128
    v_exp_f32 v129, v129
    v_exp_f32 v130, v130
    v_exp_f32 v131, v131
    v_mfma_f32_32x32x16_bf16 v[144:159], v[68:71], v[252:255], v[144:159]
    v_exp_f32 v132, v132
    v_exp_f32 v133, v133
    v_exp_f32 v134, v134
    v_exp_f32 v135, v135
    v_smfmac_f32_32x32x32_bf16 v[176:191], v[76:79], v[120:127], v27
    buffer_load_dwordx4 v[56:59], v17, s[48:51], s9 offen offset:2048 sc1
    v_exp_f32 v136, v136
    v_exp_f32 v137, v137
    v_exp_f32 v138, v138
    v_exp_f32 v139, v139
    v_smfmac_f32_32x32x32_bf16 v[192:207], v[72:75], v[128:135], v27
    s_waitcnt vmcnt(7)
    v_exp_f32 v140, v140
    v_exp_f32 v141, v141
    v_exp_f32 v142, v142
    v_exp_f32_e64 v143, v143
    v_mfma_f32_32x32x16_bf16 v[96:111], v[80:83], v[224:227], 0
    v_exp_f32 v144, v144
    v_exp_f32 v145, v145
    v_exp_f32 v146, v146
    v_exp_f32 v147, v147
    v_mfma_f32_32x32x16_bf16 v[96:111], v[84:87], v[228:231], v[96:111]
    s_and_b32 s18, s16, s17
    v_exp_f32 v148, v148
    v_exp_f32 v149, v149
    v_exp_f32 v150, v150
    v_exp_f32_e64 v151, v151
    v_smfmac_f32_32x32x32_bf16 v[192:207], v[76:79], v[136:143], v27
    buffer_load_dwordx4 v[60:63], v17, s[48:51], s9 offen offset:3072 sc1
    s_cbranch_scc0 co_sq51
co_ok50:
    v_exp_f32 v152, v152
    v_exp_f32 v153, v153
    v_exp_f32 v154, v154
    v_exp_f32_e64 v155, v155
    v_smfmac_f32_32x32x32_bf16 v[208:223], v[72:75], v[144:151], v27
    buffer_load_dwordx2 v[12:13], v16, s[48:51], s74 offen sc1
    s_ff1_i32_b32 s18, s18
    v_exp_f32 v156, v156
    v_exp_f32 v157, v157
    v_exp_f32 v158, v158
    v_exp_f32_e64 v159, v159
    v_mfma_f32_32x32x16_bf16 v[112:127], v[80:83], v[232:235], 0
    s_lshl_b32 s9, s18, 14
    v_exp_f32 v96, v96
    v_exp_f32 v97, v97
    v_exp_f32 v98, v98
    v_exp_f32_e64 v99, v99
    v_mfma_f32_32x32x16_bf16 v[112:127], v[84:87], v[236:239], v[112:127]
    s_and_b32 s9, s9, 0x3c000
    v_exp_f32 v100, v100
    v_exp_f32 v101, v101
    v_exp_f32 v102, v102
    v_exp_f32 v103, v103
    v_smfmac_f32_32x32x32_bf16 v[208:223], v[76:79], v[152:159], v27
    buffer_load_dwordx4 v[64:67], v17, s[48:51], s9 offen offset:0 sc1
    s_bitset0_b32 s17, s18
    v_exp_f32 v104, v104
    v_exp_f32 v105, v105
    v_exp_f32 v106, v106
    v_exp_f32_e64 v107, v107
    v_smfmac_f32_32x32x32_bf16 v[160:175], v[88:91], v[96:103], v27
    v_exp_f32 v108, v108
    v_exp_f32 v109, v109
    v_exp_f32 v110, v110
    v_exp_f32 v111, v111
    v_mfma_f32_32x32x16_bf16 v[128:143], v[80:83], v[240:243], 0
    v_exp_f32 v112, v112
    v_exp_f32 v113, v113
    v_exp_f32 v114, v114
    v_exp_f32 v115, v115
    v_mfma_f32_32x32x16_bf16 v[128:143], v[84:87], v[244:247], v[128:143]
    v_exp_f32 v116, v116
    v_exp_f32 v117, v117
    v_exp_f32 v118, v118
    v_exp_f32 v119, v119
    v_smfmac_f32_32x32x32_bf16 v[160:175], v[92:95], v[104:111], v27
    buffer_load_dwordx4 v[68:71], v17, s[48:51], s9 offen offset:1024 sc1
    v_exp_f32 v120, v120
    v_exp_f32 v121, v121
    v_exp_f32 v122, v122
    v_exp_f32 v123, v123
    v_smfmac_f32_32x32x32_bf16 v[176:191], v[88:91], v[112:119], v27
    v_exp_f32 v124, v124
    v_exp_f32 v125, v125
    v_exp_f32 v126, v126
    v_exp_f32 v127, v127
    v_mfma_f32_32x32x16_bf16 v[144:159], v[80:83], v[248:251], 0
    v_exp_f32 v128, v128
    v_exp_f32 v129, v129
    v_exp_f32 v130, v130
    v_exp_f32 v131, v131
    v_mfma_f32_32x32x16_bf16 v[144:159], v[84:87], v[252:255], v[144:159]
    v_exp_f32 v132, v132
    v_exp_f32 v133, v133
    v_exp_f32 v134, v134
    v_exp_f32 v135, v135
    v_smfmac_f32_32x32x32_bf16 v[176:191], v[92:95], v[120:127], v27
    buffer_load_dwordx4 v[72:75], v17, s[48:51], s9 offen offset:2048 sc1
    v_exp_f32 v136, v136
    v_exp_f32 v137, v137
    v_exp_f32 v138, v138
    v_exp_f32 v139, v139
    v_smfmac_f32_32x32x32_bf16 v[192:207], v[88:91], v[128:135], v27
    s_waitcnt vmcnt(8)
    v_exp_f32 v140, v140
    v_exp_f32 v141, v141
    v_exp_f32 v142, v142
    v_exp_f32_e64 v143, v143
    v_mfma_f32_32x32x16_bf16 v[96:111], v[32:35], v[224:227], 0
    v_exp_f32 v144, v144
    v_exp_f32 v145, v145
    v_exp_f32 v146, v146
    v_exp_f32 v147, v147
    v_mfma_f32_32x32x16_bf16 v[96:111], v[36:39], v[228:231], v[96:111]
    s_and_b32 s18, s16, s17
    v_exp_f32 v148, v148
    v_exp_f32 v149, v149
    v_exp_f32 v150, v150
    v_exp_f32_e64 v151, v151
    v_smfmac_f32_32x32x32_bf16 v[192:207], v[92:95], v[136:143], v27
    buffer_load_dwordx4 v[76:79], v17, s[48:51], s9 offen offset:3072 sc1
    s_cbranch_scc0 co_sq56
co_ok55:
    v_exp_f32 v152, v152
    v_exp_f32 v153, v153
    v_exp_f32 v154, v154
    v_exp_f32_e64 v155, v155
    v_smfmac_f32_32x32x32_bf16 v[208:223], v[88:91], v[144:151], v27
    s_ff1_i32_b32 s18, s18
    v_exp_f32 v156, v156
    v_exp_f32 v157, v157
    v_exp_f32 v158, v158
    v_exp_f32_e64 v159, v159
L_lp0:
    v_mfma_f32_32x32x16_bf16 v[112:127], v[32:35], v[232:235], 0
    s_lshl_b32 s9, s18, 14
    v_exp_f32 v96, v96
    v_exp_f32 v97, v97
    v_exp_f32 v98, v98
    v_exp_f32_e64 v99, v99
    v_mfma_f32_32x32x16_bf16 v[112:127], v[36:39], v[236:239], v[112:127]
    s_and_b32 s9, s9, 0x3c000
    v_exp_f32 v100, v100
    v_exp_f32 v101, v101
    v_exp_f32 v102, v102
    v_exp_f32 v103, v103
    v_smfmac_f32_32x32x32_bf16 v[208:223], v[92:95], v[152:159], v27
    buffer_load_dwordx4 v[80:83], v17, s[48:51], s9 offen offset:0 sc1
    s_bitset0_b32 s17, s18
    v_exp_f32 v104, v104
    v_exp_f32 v105, v105
    v_exp_f32 v106, v106
    v_exp_f32_e64 v107, v107
    v_smfmac_f32_32x32x32_bf16 v[160:175], v[40:43], v[96:103], v27
    v_exp_f32 v108, v108
    v_exp_f32 v109, v109
    v_exp_f32 v110, v110
    v_exp_f32 v111, v111
    v_mfma_f32_32x32x16_bf16 v[128:143], v[32:35], v[240:243], 0
    s_cmp_eq_u32 s17, 0
    v_exp_f32 v112, v112
    v_exp_f32 v113, v113
    v_exp_f32 v114, v114
    v_exp_f32_e64 v115, v115
    v_mfma_f32_32x32x16_bf16 v[128:143], v[36:39], v[244:247], v[128:143]
    s_cselect_b32 s17, 15, s17
    v_exp_f32 v116, v116
    v_exp_f32 v117, v117
    v_exp_f32 v118, v118
    v_exp_f32_e64 v119, v119
    v_smfmac_f32_32x32x32_bf16 v[160:175], v[44:47], v[104:111], v27
    buffer_load_dwordx4 v[84:87], v17, s[48:51], s9 offen offset:1024 sc1
    v_exp_f32 v120, v120
    v_exp_f32 v121, v121
    v_exp_f32 v122, v122
    v_exp_f32 v123, v123
    v_smfmac_f32_32x32x32_bf16 v[176:191], v[40:43], v[112:119], v27
    v_exp_f32 v124, v124
    v_exp_f32 v125, v125
    v_exp_f32 v126, v126
    v_exp_f32 v127, v127
    v_mfma_f32_32x32x16_bf16 v[144:159], v[32:35], v[248:251], 0
    v_exp_f32 v128, v128
    v_exp_f32 v129, v129
    v_exp_f32 v130, v130
    v_exp_f32 v131, v131
    v_mfma_f32_32x32x16_bf16 v[144:159], v[36:39], v[252:255], v[144:159]
    v_exp_f32 v132, v132
    v_exp_f32 v133, v133
    v_exp_f32 v134, v134
    v_exp_f32 v135, v135
    v_smfmac_f32_32x32x32_bf16 v[176:191], v[44:47], v[120:127], v27
    buffer_load_dwordx4 v[88:91], v17, s[48:51], s9 offen offset:2048 sc1
    v_exp_f32 v136, v136
    v_exp_f32 v137, v137
    v_exp_f32 v138, v138
    v_exp_f32 v139, v139
    v_smfmac_f32_32x32x32_bf16 v[192:207], v[40:43], v[128:135], v27
    s_waitcnt vmcnt(7)
    v_cmp_eq_u64 vcc, v[12:13], v[8:9]
    v_exp_f32 v140, v140
    v_exp_f32 v141, v141
    v_exp_f32 v142, v142
    v_exp_f32 v143, v143
    v_mfma_f32_32x32x16_bf16 v[96:111], v[48:51], v[232:235], 0
    s_and_b32 s16, vcc_lo, vcc_hi
    v_exp_f32 v144, v144
    v_exp_f32 v145, v145
    v_exp_f32 v146, v146
    v_exp_f32_e64 v147, v147
    v_mfma_f32_32x32x16_bf16 v[96:111], v[52:55], v[236:239], v[96:111]
    s_and_b32 s18, s16, s17
    v_exp_f32 v148, v148
    v_exp_f32 v149, v149
    v_exp_f32 v150, v150
    v_exp_f32_e64 v151, v151
    v_smfmac_f32_32x32x32_bf16 v[192:207], v[44:47], v[136:143], v27
    buffer_load_dwordx4 v[92:95], v17, s[48:51], s9 offen offset:3072 sc1
    s_cbranch_scc0 co_sq61
co_ok60:
    v_exp_f32 v152, v152
    v_exp_f32 v153, v153
    v_exp_f32 v154, v154
    v_exp_f32_e64 v155, v155
    v_smfmac_f32_32x32x32_bf16 v[208:223], v[40:43], v[144:151], v27
    s_ff1_i32_b32 s18, s18
    s_sub_u32 s12, s12, 1
    v_exp_f32 v156, v156
    v_exp_f32 v157, v157
    v_exp_f32_e64 v158, v158
    v_exp_f32 v159, v159
    s_cbranch_scc0 L_loop
    v_mov_b32 v36, 65536
    s_waitcnt vmcnt(7)
    v_mfma_f32_32x32x16_bf16 v[112:127], v[64:67], v[232:235], 0
    v_exp_f32 v96, v96
    s_add_u32 s11, s3, 1
    v_exp_f32 v97, v97
    s_and_b32 s11, s11, 3
    v_exp_f32 v98, v98
    s_mul_i32 s11, s11, 12288
    v_exp_f32_e64 v99, v99
    v_add3_u32 v33, s11, v5, v36
    s_waitcnt vmcnt(6)
    v_mfma_f32_32x32x16_bf16 v[112:127], v[68:71], v[236:239], v[112:127]
    v_exp_f32 v100, v100
    s_add_u32 s11, s3, 2
    v_exp_f32 v101, v101
    s_and_b32 s11, s11, 3
    v_exp_f32 v102, v102
    s_mul_i32 s11, s11, 12288
    v_exp_f32_e64 v103, v103
    v_add3_u32 v34, s11, v5, v36
    v_smfmac_f32_32x32x32_bf16 v[208:223], v[44:47], v[152:159], v27
    v_exp_f32 v104, v104
    s_add_u32 s11, s3, 3
    v_exp_f32 v105, v105
    s_and_b32 s11, s11, 3
    v_exp_f32_e64 v106, v106
    s_mul_i32 s11, s11, 12288
    v_exp_f32_e64 v107, v107
    v_add3_u32 v35, s11, v5, v36
    v_smfmac_f32_32x32x32_bf16 v[176:191], v[56:59], v[96:103], v27
    v_exp_f32 v108, v108
    s_add_u32 s11, s3, 4
    v_exp_f32 v109, v109
    s_and_b32 s11, s11, 3
    v_exp_f32_e64 v110, v110
    s_mul_i32 s11, s11, 12288
    v_exp_f32_e64 v111, v111
    v_add3_u32 v32, s11, v5, v36
    s_waitcnt vmcnt(3)
    v_mfma_f32_32x32x16_bf16 v[128:143], v[80:83], v[232:235], 0
    v_exp_f32 v112, v112
    v_exp_f32 v113, v113
    v_exp_f32 v114, v114
    v_exp_f32 v115, v115
    s_waitcnt vmcnt(2)
    v_mfma_f32_32x32x16_bf16 v[128:143], v[84:87], v[236:239], v[128:143]
    v_exp_f32 v116, v116
    v_exp_f32 v117, v117
    v_exp_f32 v118, v118
    v_exp_f32 v119, v119
    v_smfmac_f32_32x32x32_bf16 v[176:191], v[60:63], v[104:111], v27
    v_exp_f32 v120, v120
    v_exp_f32 v121, v121
    v_exp_f32 v122, v122
    v_exp_f32 v123, v123
    v_smfmac_f32_32x32x32_bf16 v[176:191], v[72:75], v[112:119], v27
    v_exp_f32 v124, v124
    v_exp_f32 v125, v125
    v_exp_f32 v126, v126
    v_exp_f32 v127, v127
    v_mfma_f32_32x32x16_bf16 v[144:159], v[48:51], v[240:243], 0
    v_exp_f32 v128, v128
    v_exp_f32 v129, v129
    v_exp_f32 v130, v130
    v_exp_f32 v131, v131
    v_mfma_f32_32x32x16_bf16 v[144:159], v[52:55], v[244:247], v[144:159]
    v_exp_f32 v132, v132
    v_exp_f32 v133, v133
    v_exp_f32 v134, v134
    v_exp_f32 v135, v135
    v_smfmac_f32_32x32x32_bf16 v[176:191], v[76:79], v[120:127], v27
    v_exp_f32 v136, v136
    v_exp_f32 v137, v137
    v_exp_f32_e64 v138, v138
    v_exp_f32 v139, v139
    s_waitcnt vmcnt(1)
    v_smfmac_f32_32x32x32_bf16 v[176:191], v[88:91], v[128:135], v27
    v_exp_f32 v140, v140
    v_exp_f32 v141, v141
    ds_read_b32 v7, v4 offset:3072
    v_exp_f32 v142, v142
    v_exp_f32 v143, v143
    s_waitcnt vmcnt(0)
    s_nop 0
    v_smfmac_f32_32x32x32_bf16 v[176:191], v[92:95], v[136:143], v27
    v_exp_f32 v144, v144
    v_exp_f32 v145, v145
    v_exp_f32 v146, v146
    v_exp_f32 v147, v147
    v_mfma_f32_32x32x16_bf16 v[96:111], v[64:67], v[240:243], 0
    v_exp_f32 v148, v148
    v_exp_f32 v149, v149
    v_exp_f32 v150, v150
    v_exp_f32 v151, v151
    v_mfma_f32_32x32x16_bf16 v[96:111], v[68:71], v[244:247], v[96:111]
    v_exp_f32 v152, v152
    s_waitcnt lgkmcnt(0)
    v_readfirstlane_b32 s47, v7
    s_nop 0
    s_cmp_lt_u32 s47, 4
    s_cbranch_scc1 co_sp65
co_ok66:
    v_exp_f32_e64 v153, v153
    ds_write_b128 v33, v[176:179] offset:0
    v_exp_f32 v154, v154
    v_exp_f32 v155, v155
    v_smfmac_f32_32x32x32_bf16 v[192:207], v[56:59], v[144:151], v27
    v_exp_f32 v156, v156
    v_exp_f32 v157, v157
    v_exp_f32 v158, v158
    v_exp_f32 v159, v159
    v_mfma_f32_32x32x16_bf16 v[112:127], v[80:83], v[240:243], 0
    v_exp_f32 v96, v96
    v_exp_f32 v97, v97
    ds_write_b128 v33, v[180:183] offset:1024
    v_exp_f32 v98, v98
    v_exp_f32 v99, v99
    v_mfma_f32_32x32x16_bf16 v[112:127], v[84:87], v[244:247], v[112:127]
    v_exp_f32 v100, v100
    v_exp_f32 v101, v101
    v_exp_f32 v102, v102
    v_exp_f32 v103, v103
    v_smfmac_f32_32x32x32_bf16 v[192:207], v[60:63], v[152:159], v27
    v_exp_f32 v104, v104
    v_exp_f32 v105, v105
    ds_write_b128 v33, v[184:187] offset:2048
    v_exp_f32 v106, v106
    v_exp_f32 v107, v107
    v_smfmac_f32_32x32x32_bf16 v[192:207], v[72:75], v[96:103], v27
    v_exp_f32 v108, v108
    v_exp_f32 v109, v109
    v_exp_f32 v110, v110
    v_exp_f32 v111, v111
    v_mfma_f32_32x32x16_bf16 v[128:143], v[48:51], v[248:251], 0
    v_exp_f32 v112, v112
    v_exp_f32 v113, v113
    ds_write_b128 v33, v[188:191] offset:3072
    v_exp_f32 v114, v114
    v_exp_f32 v115, v115
    v_mfma_f32_32x32x16_bf16 v[128:143], v[52:55], v[252:255], v[128:143]
    v_exp_f32 v116, v116
    v_exp_f32 v117, v117
    v_exp_f32 v118, v118
    v_exp_f32 v119, v119
    v_smfmac_f32_32x32x32_bf16 v[192:207], v[76:79], v[104:111], v27
    v_exp_f32 v120, v120
    v_exp_f32 v121, v121
    v_exp_f32 v122, v122
    v_exp_f32 v123, v123
    v_smfmac_f32_32x32x32_bf16 v[192:207], v[88:91], v[112:119], v27
    v_exp_f32 v124, v124
    v_exp_f32 v125, v125
    v_exp_f32_e64 v126, v126
    v_exp_f32 v127, v127
    s_nop 1
    v_smfmac_f32_32x32x32_bf16 v[192:207], v[92:95], v[120:127], v27
    v_exp_f32 v128, v128
    v_exp_f32 v129, v129
    v_exp_f32 v130, v130
    v_exp_f32 v131, v131
    v_mfma_f32_32x32x16_bf16 v[144:159], v[64:67], v[248:251], 0
    v_exp_f32 v132, v132
    v_exp_f32 v133, v133
    v_exp_f32 v134, v134
    v_exp_f32 v135, v135
    v_mfma_f32_32x32x16_bf16 v[144:159], v[68:71], v[252:255], v[144:159]
    v_exp_f32 v136, v136
    v_exp_f32 v137, v137
    ds_write_b128 v34, v[192:195] offset:4096
    v_exp_f32 v138, v138
    v_exp_f32 v139, v139
    v_smfmac_f32_32x32x32_bf16 v[208:223], v[56:59], v[128:135], v27
    v_exp_f32 v140, v140
    v_exp_f32 v141, v141
    v_exp_f32 v142, v142
    v_exp_f32 v143, v143
    v_mfma_f32_32x32x16_bf16 v[96:111], v[80:83], v[248:251], 0
    s_nop 0
    v_exp_f32 v144, v144
    v_exp_f32_e64 v145, v145
    ds_write_b128 v34, v[196:199] offset:5120
    v_exp_f32 v146, v146
    v_exp_f32 v147, v147
    v_mfma_f32_32x32x16_bf16 v[96:111], v[84:87], v[252:255], v[96:111]
    v_exp_f32 v148, v148
    v_exp_f32 v149, v149
    v_exp_f32 v150, v150
    v_exp_f32 v151, v151
    v_smfmac_f32_32x32x32_bf16 v[208:223], v[60:63], v[136:143], v27
    v_exp_f32 v152, v152
    v_exp_f32 v153, v153
    ds_write_b128 v34, v[200:203] offset:6144
    v_exp_f32 v154, v154
    v_exp_f32 v155, v155
    v_smfmac_f32_32x32x32_bf16 v[208:223], v[72:75], v[144:151], v27
    v_exp_f32 v156, v156
    v_exp_f32 v157, v157
    v_exp_f32 v158, v158
    v_exp_f32 v159, v159
    v_mfma_f32_32x32x16_bf16 v[112:127], v[48:51], v[224:227], 0
    v_exp_f32 v96, v96
    v_exp_f32 v97, v97
    ds_write_b128 v34, v[204:207] offset:7168
    v_exp_f32 v98, v98
    v_exp_f32 v99, v99
    v_mfma_f32_32x32x16_bf16 v[112:127], v[52:55], v[228:231], v[112:127]
    v_exp_f32 v100, v100
    v_exp_f32 v101, v101
    v_exp_f32 v102, v102
    v_exp_f32 v103, v103
    v_smfmac_f32_32x32x32_bf16 v[208:223], v[76:79], v[152:159], v27
    v_exp_f32 v104, v104
    v_exp_f32 v105, v105
    v_exp_f32 v106, v106
    v_exp_f32 v107, v107
    v_smfmac_f32_32x32x32_bf16 v[208:223], v[88:91], v[96:103], v27
    v_exp_f32 v108, v108
    v_exp_f32 v109, v109
    v_exp_f32_e64 v110, v110
    v_exp_f32 v111, v111
    s_nop 1
    v_smfmac_f32_32x32x32_bf16 v[208:223], v[92:95], v[104:111], v27
    v_exp_f32 v112, v112
    v_exp_f32 v113, v113
    v_exp_f32 v114, v114
    v_exp_f32 v115, v115
    v_mfma_f32_32x32x16_bf16 v[128:143], v[64:67], v[224:227], 0
    v_exp_f32 v116, v116
    v_exp_f32 v117, v117
    v_exp_f32 v118, v118
    v_exp_f32 v119, v119
    v_mfma_f32_32x32x16_bf16 v[128:143], v[68:71], v[228:231], v[128:143]
    v_exp_f32 v120, v120
    v_exp_f32 v121, v121
    ds_write_b128 v35, v[208:211] offset:8192
    v_exp_f32 v122, v122
    v_exp_f32 v123, v123
    ds_write_b128 v35, v[212:215] offset:9216
    v_smfmac_f32_32x32x32_bf16 v[160:175], v[56:59], v[112:119], v27
    v_exp_f32 v124, v124
    v_exp_f32 v125, v125
    ds_write_b128 v35, v[216:219] offset:10240
    v_exp_f32 v126, v126
    v_exp_f32 v127, v127
    ds_write_b128 v35, v[220:223] offset:11264
    ds_add_u32 v4, v6 offset:3328
    v_mfma_f32_32x32x16_bf16 v[144:159], v[80:83], v[224:227], 0
    v_exp_f32 v128, v128
    v_exp_f32 v129, v129
    v_exp_f32 v130, v130
    v_exp_f32 v131, v131
    v_mfma_f32_32x32x16_bf16 v[144:159], v[84:87], v[228:231], v[144:159]
    v_exp_f32 v132, v132
    v_exp_f32 v133, v133
    v_exp_f32 v134, v134
    v_exp_f32 v135, v135
    v_smfmac_f32_32x32x32_bf16 v[160:175], v[60:63], v[120:127], v27
    v_exp_f32 v136, v136
    v_exp_f32 v137, v137
    v_exp_f32 v138, v138
    v_exp_f32 v139, v139
    v_smfmac_f32_32x32x32_bf16 v[160:175], v[72:75], v[128:135], v27
    v_exp_f32 v140, v140
    v_exp_f32 v141, v141
    v_exp_f32_e64 v142, v142
    v_exp_f32 v143, v143
    s_nop 1
    v_smfmac_f32_32x32x32_bf16 v[160:175], v[76:79], v[136:143], v27
    v_exp_f32_e64 v144, v144
    ds_read_b32 v7, v4 offset:3328
    v_exp_f32 v145, v145
    v_exp_f32 v146, v146
    v_exp_f32 v147, v147
    v_exp_f32 v148, v148
    v_exp_f32 v149, v149
    v_exp_f32 v150, v150
    v_exp_f32 v151, v151
    s_nop 1
    v_smfmac_f32_32x32x32_bf16 v[160:175], v[88:91], v[144:151], v27
    v_exp_f32 v152, v152
    s_waitcnt lgkmcnt(0)
    v_readfirstlane_b32 s47, v7
    s_nop 0
    s_cmp_lt_u32 s47, 4
    s_cbranch_scc1 co_sp67
co_ok68:
    ds_read_b128 v[176:179], v32 offset:0
    v_exp_f32_e64 v153, v153
    ds_read_b128 v[180:183], v32 offset:1024
    v_exp_f32_e64 v154, v154
    ds_read_b128 v[184:187], v32 offset:2048
    v_exp_f32_e64 v155, v155
    ds_read_b128 v[188:191], v32 offset:3072
    v_exp_f32_e64 v156, v156
    ds_read_b128 v[192:195], v32 offset:4096
    v_exp_f32_e64 v157, v157
    ds_read_b128 v[196:199], v32 offset:5120
    v_exp_f32_e64 v158, v158
    ds_read_b128 v[200:203], v32 offset:6144
    v_exp_f32_e64 v159, v159
    ds_read_b128 v[204:207], v32 offset:7168
    ds_read_b128 v[208:211], v32 offset:8192
    ds_read_b128 v[212:215], v32 offset:9216
    ds_read_b128 v[216:219], v32 offset:10240
    ds_read_b128 v[220:223], v32 offset:11264
    v_smfmac_f32_32x32x32_bf16 v[160:175], v[92:95], v[152:159], v27
    s_lshl_b32 s11, s8, 4
    s_add_u32 s11, s11, s75
    v_and_b32 v17, 3, v1
    v_mul_u32_u24 v17, 0x6ef372, v17
    v_add_u32 v17, 0x9e3779b1, v17
    v_xor_b32 v2, v8, v9
    v_mul_lo_u32 v17, v17, v2
    v_lshrrev_b32 v17, 19, v17
    v_or_b32 v17, 0x4000, v17
    v_lshlrev_b32 v17, 16, v17
    s_lshl_b32 s11, s11, 11
    s_add_u32 s11, s11, 6291456
    s_waitcnt lgkmcnt(7)
    v_pk_add_f32 v[176:177], v[176:177], v[192:193]
    v_pk_add_f32 v[178:179], v[178:179], v[194:195]
    s_waitcnt lgkmcnt(6)
    v_pk_add_f32 v[180:181], v[180:181], v[196:197]
    v_pk_add_f32 v[182:183], v[182:183], v[198:199]
    s_waitcnt lgkmcnt(5)
    v_pk_add_f32 v[184:185], v[184:185], v[200:201]
    v_pk_add_f32 v[186:187], v[186:187], v[202:203]
    s_waitcnt lgkmcnt(4)
    v_pk_add_f32 v[188:189], v[188:189], v[204:205]
    v_pk_add_f32 v[190:191], v[190:191], v[206:207]
    s_waitcnt lgkmcnt(3)
    v_pk_add_f32 v[176:177], v[176:177], v[208:209]
    v_pk_add_f32 v[178:179], v[178:179], v[210:211]
    s_waitcnt lgkmcnt(2)
    v_pk_add_f32 v[180:181], v[180:181], v[212:213]
    v_pk_add_f32 v[182:183], v[182:183], v[214:215]
    s_waitcnt lgkmcnt(1)
    v_pk_add_f32 v[184:185], v[184:185], v[216:217]
    v_pk_add_f32 v[186:187], v[186:187], v[218:219]
    s_waitcnt lgkmcnt(0)
    v_pk_add_f32 v[188:189], v[188:189], v[220:221]
    v_pk_add_f32 v[190:191], v[190:191], v[222:223]
    v_pk_add_f32 v[160:161], v[160:161], v[176:177]
    v_pk_add_f32 v[162:163], v[162:163], v[178:179]
    v_pk_add_f32 v[164:165], v[164:165], v[180:181]
    v_pk_add_f32 v[166:167], v[166:167], v[182:183]
    v_pk_add_f32 v[168:169], v[168:169], v[184:185]
    v_pk_add_f32 v[170:171], v[170:171], v[186:187]
    v_pk_add_f32 v[172:173], v[172:173], v[188:189]
    v_pk_add_f32 v[174:175], v[174:175], v[190:191]
    s_lshl_b32 s10, s8, 4
    s_add_u32 s10, s10, s75
    s_lshl_b32 s10, s10, 9
    s_add_u32 s10, s10, 14745600
    v_lshlrev_b32 v2, 3, v1
    s_mov_b64 exec, 0xffff
    buffer_store_dwordx2 v[8:9], v2, s[48:51], s10 offen sc1
    s_mov_b64 exec, -1
    v_mov_b32 v18, v175
    v_mov_b32 v20, v175
    v_pk_add_f32 v[176:177], v[160:161], v[168:169]
    v_pk_add_f32 v[178:179], v[162:163], v[170:171]
    v_pk_add_f32 v[180:181], v[164:165], v[172:173]
    v_pk_add_f32 v[182:183], v[166:167], v[174:175]
    v_permlane32_swap_b32 v18, v20
    v_pk_add_f32 v[176:177], v[176:177], v[180:181]
    v_pk_add_f32 v[178:179], v[178:179], v[182:183]
    v_pk_add_f32 v[176:177], v[176:177], v[178:179]
    v_add_f32 v176, v176, v177
    v_mov_b32 v177, 0x207
    v_cmp_class_f32 s[14:15], v176, v177
    v_cmp_nle_f32 vcc, 0x30800000, v20
    s_nop 0
    s_or_b64 s[14:15], s[14:15], vcc
    v_cmp_nge_f32 vcc, 0x4e800000, v20
    s_nop 0
    s_or_b64 s[14:15], s[14:15], vcc
    s_cmp_lg_u64 s[14:15], 0
    s_cbranch_scc1 L_fb
L_fin:
    v_rcp_f32 v20, v20
    s_nop 3
    v_pk_mul_f32 v[160:161], v[160:161], v[20:21] op_sel:[0,0] op_sel_hi:[1,0]
    v_pk_mul_f32 v[162:163], v[162:163], v[20:21] op_sel:[0,0] op_sel_hi:[1,0]
    v_pk_mul_f32 v[164:165], v[164:165], v[20:21] op_sel:[0,0] op_sel_hi:[1,0]
    v_pk_mul_f32 v[166:167], v[166:167], v[20:21] op_sel:[0,0] op_sel_hi:[1,0]
    v_pk_mul_f32 v[168:169], v[168:169], v[20:21] op_sel:[0,0] op_sel_hi:[1,0]
    v_pk_mul_f32 v[170:171], v[170:171], v[20:21] op_sel:[0,0] op_sel_hi:[1,0]
    v_pk_mul_f32 v[172:173], v[172:173], v[20:21] op_sel:[0,0] op_sel_hi:[1,0]
    v_pk_mul_f32 v[174:175], v[174:175], v[20:21] op_sel:[0,0] op_sel_hi:[1,0]
    v_cvt_pk_bf16_f32 v176, v160, v161
    v_cvt_pk_bf16_f32 v177, v162, v163
    v_cvt_pk_bf16_f32 v178, v164, v165
    v_cvt_pk_bf16_f32 v179, v166, v17
    v_cvt_pk_bf16_f32 v180, v168, v169
    v_cvt_pk_bf16_f32 v181, v170, v171
    v_cvt_pk_bf16_f32 v182, v172, v173
    v_cvt_pk_bf16_f32 v183, v174, v17
    buffer_store_dwordx4 v[176:179], v5, s[48:51], s11 offen offset:0 sc1
    buffer_store_dwordx4 v[180:183], v5, s[48:51], s11 offen offset:1024 sc1
    s_endpgm
L_fb:
    s_waitcnt vmcnt(0)
    s_lshl_b32 s74, s5, 12
    s_add_u32 s74, s74, 14712832
    buffer_load_dwordx2 v[10:11], v16, s[48:51], s74 offen sc1
    s_waitcnt vmcnt(0)
    v_cmp_ne_u64 vcc, v[10:11], v[8:9]
    s_nop 0
    s_cbranch_vccnz co_sq70
co_ok72:
    s_lshl_b32 s74, s5, 12
    s_add_u32 s74, s74, 14712960
    buffer_load_dwordx2 v[10:11], v16, s[48:51], s74 offen sc1
    s_waitcnt vmcnt(0)
    v_cmp_ne_u64 vcc, v[10:11], v[8:9]
    s_nop 0
    s_cbranch_vccnz co_sq73
co_ok75:
    s_lshl_b32 s74, s5, 12
    s_add_u32 s74, s74, 14713088
    buffer_load_dwordx2 v[10:11], v16, s[48:51], s74 offen sc1
    s_waitcnt vmcnt(0)
    v_cmp_ne_u64 vcc, v[10:11], v[8:9]
    s_nop 0
    s_cbranch_vccnz co_sq76
co_ok78:
    s_lshl_b32 s74, s5, 12
    s_add_u32 s74, s74, 14713216
    buffer_load_dwordx2 v[10:11], v16, s[48:51], s74 offen sc1
    s_waitcnt vmcnt(0)
    v_cmp_ne_u64 vcc, v[10:11], v[8:9]
    s_nop 0
    s_cbranch_vccnz co_sq79
co_ok81:
    s_lshl_b32 s13, s75, 18
    s_add_u32 s13, s13, 2097152
    s_mov_b32 s9, s13
    s_mov_b32 s12, 64
    v_mov_b32 v22, 0xff800000
L_fb1:
    buffer_load_dwordx4 v[32:35], v5, s[48:51], s9 offen offset:0 sc1
    buffer_load_dwordx4 v[36:39], v5, s[48:51], s9 offen offset:1024 sc1
    s_add_u32 s9, s9, 4096
    s_waitcnt vmcnt(1)
    v_mfma_f32_32x32x16_bf16 v[96:111], v[32:35], v[224:227], 0
    s_waitcnt vmcnt(0)
    v_mfma_f32_32x32x16_bf16 v[96:111], v[36:39], v[228:231], v[96:111]
    s_nop 11
    v_max3_f32 v22, v22, v96, v97
    v_max3_f32 v22, v22, v98, v99
    v_max3_f32 v22, v22, v100, v101
    v_max3_f32 v22, v22, v102, v103
    v_max3_f32 v22, v22, v104, v105
    v_max3_f32 v22, v22, v106, v107
    v_max3_f32 v22, v22, v108, v109
    v_max3_f32 v22, v22, v110, v111
    s_sub_u32 s12, s12, 1
    s_cmp_lg_u32 s12, 0
    s_cbranch_scc1 L_fb1
    v_mov_b32 v18, v22
    s_nop 1
    v_permlane32_swap_b32 v18, v22
    v_max_f32 v22, v22, v18
    v_mov_b32 v160, 0
    v_mov_b32 v161, 0
    v_mov_b32 v162, 0
    v_mov_b32 v163, 0
    v_mov_b32 v164, 0
    v_mov_b32 v165, 0
    v_mov_b32 v166, 0
    v_mov_b32 v167, 0
    v_mov_b32 v168, 0
    v_mov_b32 v169, 0
    v_mov_b32 v170, 0
    v_mov_b32 v171, 0
    v_mov_b32 v172, 0
    v_mov_b32 v173, 0
    v_mov_b32 v174, 0
    v_mov_b32 v175, 0
    s_mov_b32 s9, s13
    s_mov_b32 s12, 64
L_fb2:
    buffer_load_dwordx4 v[32:35], v5, s[48:51], s9 offen offset:0 sc1
    buffer_load_dwordx4 v[36:39], v5, s[48:51], s9 offen offset:1024 sc1
    buffer_load_dwordx4 v[40:43], v5, s[48:51], s9 offen offset:2048 sc1
    buffer_load_dwordx4 v[44:47], v5, s[48:51], s9 offen offset:3072 sc1
    s_add_u32 s9, s9, 4096
    s_waitcnt vmcnt(3)
    v_mfma_f32_32x32x16_bf16 v[96:111], v[32:35], v[224:227], 0
    s_waitcnt vmcnt(2)
    v_mfma_f32_32x32x16_bf16 v[96:111], v[36:39], v[228:231], v[96:111]
    s_nop 11
    v_sub_f32 v96, v96, v22
    v_sub_f32 v97, v97, v22
    v_sub_f32 v98, v98, v22
    v_sub_f32 v99, v99, v22
    v_sub_f32 v100, v100, v22
    v_sub_f32 v101, v101, v22
    v_sub_f32 v102, v102, v22
    v_sub_f32 v103, v103, v22
    v_sub_f32 v104, v104, v22
    v_sub_f32 v105, v105, v22
    v_sub_f32 v106, v106, v22
    v_sub_f32 v107, v107, v22
    v_sub_f32 v108, v108, v22
    v_sub_f32 v109, v109, v22
    v_sub_f32 v110, v110, v22
    v_sub_f32 v111, v111, v22
    v_exp_f32 v96, v96
    v_exp_f32 v97, v97
    v_exp_f32 v98, v98
    v_exp_f32 v99, v99
    v_exp_f32 v100, v100
    v_exp_f32 v101, v101
    v_exp_f32 v102, v102
    v_exp_f32 v103, v103
    v_exp_f32 v104, v104
    v_exp_f32 v105, v105
    v_exp_f32 v106, v106
    v_exp_f32 v107, v107
    v_exp_f32 v108, v108
    v_exp_f32 v109, v109
    v_exp_f32 v110, v110
    v_exp_f32 v111, v111
    s_waitcnt vmcnt(1)
    v_smfmac_f32_32x32x32_bf16 v[160:175], v[40:43], v[96:103], v27
    s_waitcnt vmcnt(0)
    v_smfmac_f32_32x32x32_bf16 v[160:175], v[44:47], v[104:111], v27
    s_sub_u32 s12, s12, 1
    s_cmp_lg_u32 s12, 0
    s_cbranch_scc1 L_fb2
    s_nop 8
    v_mov_b32 v18, v175
    v_mov_b32 v20, v175
    s_nop 1
    v_permlane32_swap_b32 v18, v20
    s_branch L_fin
co_sp2:
    ds_read_b32 v7, v26 offset:0
    s_add_u32 s46, s46, 1
    s_cmp_gt_u32 s46, 262144
    s_cbranch_scc1 co_ok3
    s_waitcnt lgkmcnt(0)
    v_cmp_ne_u32 vcc, 0, v7
    s_nop 0
    s_cbranch_vccnz co_sp2
    s_branch co_ok3
co_sp4:
    ds_read_b32 v7, v26 offset:4
    s_add_u32 s46, s46, 1
    s_cmp_gt_u32 s46, 262144
    s_cbranch_scc1 co_ok5
    s_waitcnt lgkmcnt(0)
    v_cmp_ne_u32 vcc, 0, v7
    s_nop 0
    s_cbranch_vccnz co_sp4
    s_branch co_ok5
co_sp6:
    ds_read_b32 v7, v26 offset:8
    s_add_u32 s46, s46, 1
    s_cmp_gt_u32 s46, 262144
    s_cbranch_scc1 co_ok7
    s_waitcnt lgkmcnt(0)
    v_cmp_ne_u32 vcc, 0, v7
    s_nop 0
    s_cbranch_vccnz co_sp6
    s_branch co_ok7
co_sp8:
    ds_read_b32 v7, v26 offset:12
    s_add_u32 s46, s46, 1
    s_cmp_gt_u32 s46, 262144
    s_cbranch_scc1 co_ok9
    s_waitcnt lgkmcnt(0)
    v_cmp_ne_u32 vcc, 0, v7
    s_nop 0
    s_cbranch_vccnz co_sp8
    s_branch co_ok9
co_sp10:
    ds_read_b32 v7, v26 offset:16
    s_add_u32 s46, s46, 1
    s_cmp_gt_u32 s46, 262144
    s_cbranch_scc1 co_ok11
    s_waitcnt lgkmcnt(0)
    v_cmp_ne_u32 vcc, 0, v7
    s_nop 0
    s_cbranch_vccnz co_sp10
    s_branch co_ok11
co_sp12:
    ds_read_b32 v7, v26 offset:20
    s_add_u32 s46, s46, 1
    s_cmp_gt_u32 s46, 262144
    s_cbranch_scc1 co_ok13
    s_waitcnt lgkmcnt(0)
    v_cmp_ne_u32 vcc, 0, v7
    s_nop 0
    s_cbranch_vccnz co_sp12
    s_branch co_ok13
co_sp14:
    ds_read_b32 v7, v26 offset:24
    s_add_u32 s46, s46, 1
    s_cmp_gt_u32 s46, 262144
    s_cbranch_scc1 co_ok15
    s_waitcnt lgkmcnt(0)
    v_cmp_ne_u32 vcc, 0, v7
    s_nop 0
    s_cbranch_vccnz co_sp14
    s_branch co_ok15
co_sp16:
    ds_read_b32 v7, v26 offset:0
    s_add_u32 s46, s46, 1
    s_cmp_gt_u32 s46, 262144
    s_cbranch_scc1 co_ok17
    s_waitcnt lgkmcnt(0)
    v_cmp_ne_u32 vcc, 0, v7
    s_nop 0
    s_cbranch_vccnz co_sp16
    s_branch co_ok17
co_sp18:
    ds_read_b32 v7, v26 offset:4
    s_add_u32 s46, s46, 1
    s_cmp_gt_u32 s46, 262144
    s_cbranch_scc1 co_ok19
    s_waitcnt lgkmcnt(0)
    v_cmp_ne_u32 vcc, 0, v7
    s_nop 0
    s_cbranch_vccnz co_sp18
    s_branch co_ok19
co_sp20:
    ds_read_b32 v7, v26 offset:8
    s_add_u32 s46, s46, 1
    s_cmp_gt_u32 s46, 262144
    s_cbranch_scc1 co_ok21
    s_waitcnt lgkmcnt(0)
    v_cmp_ne_u32 vcc, 0, v7
    s_nop 0
    s_cbranch_vccnz co_sp20
    s_branch co_ok21
co_sp22:
    ds_read_b32 v7, v26 offset:12
    s_add_u32 s46, s46, 1
    s_cmp_gt_u32 s46, 262144
    s_cbranch_scc1 co_ok23
    s_waitcnt lgkmcnt(0)
    v_cmp_ne_u32 vcc, 0, v7
    s_nop 0
    s_cbranch_vccnz co_sp22
    s_branch co_ok23
co_sp24:
    ds_read_b32 v7, v26 offset:16
    s_add_u32 s46, s46, 1
    s_cmp_gt_u32 s46, 262144
    s_cbranch_scc1 co_ok25
    s_waitcnt lgkmcnt(0)
    v_cmp_ne_u32 vcc, 0, v7
    s_nop 0
    s_cbranch_vccnz co_sp24
    s_branch co_ok25
co_sp26:
    ds_read_b32 v7, v26 offset:20
    s_add_u32 s46, s46, 1
    s_cmp_gt_u32 s46, 262144
    s_cbranch_scc1 co_ok27
    s_waitcnt lgkmcnt(0)
    v_cmp_ne_u32 vcc, 0, v7
    s_nop 0
    s_cbranch_vccnz co_sp26
    s_branch co_ok27
co_sp28:
    ds_read_b32 v7, v26 offset:24
    s_add_u32 s46, s46, 1
    s_cmp_gt_u32 s46, 262144
    s_cbranch_scc1 co_ok29
    s_waitcnt lgkmcnt(0)
    v_cmp_ne_u32 vcc, 0, v7
    s_nop 0
    s_cbranch_vccnz co_sp28
    s_branch co_ok29
co_sp30:
    buffer_load_dwordx2 v[8:9], off, s[60:63], 0 sc1
    s_waitcnt vmcnt(0)
    s_add_u32 s46, s46, 1
    s_cmp_gt_u32 s46, 262144
    s_cbranch_scc1 co_ok31
    v_cmp_eq_u32 vcc, 0, v8
    s_nop 0
    s_cbranch_vccnz co_sp30
    s_branch co_ok31
co_sq33:
    s_mov_b32 s47, 12
co_sp34:
    s_sub_u32 s47, s47, 1
    s_cbranch_scc0 co_ns36
    s_mov_b64 exec, 1
    buffer_store_dwordx2 v[8:9], off, s[48:51], s73 sc1
    s_mov_b64 exec, -1
    s_bitset1_b32 s74, 15
co_ns36:
    buffer_load_dwordx2 v[10:11], v16, s[48:51], s74 offen sc1
    s_waitcnt vmcnt(0)
    s_add_u32 s46, s46, 1
    s_cmp_gt_u32 s46, 262144
    s_cbranch_scc1 co_to35
    v_cmp_eq_u64 vcc, v[10:11], v[8:9]
    v_mov_b32 v12, v10
    v_mov_b32 v13, v11
    s_and_b32 s16, vcc_lo, vcc_hi
    s_bcnt1_i32_b32 s18, s16
    s_cmp_ge_u32 s18, 8
    s_cbranch_scc0 co_sp34
    s_branch co_ok32
co_to35:
    s_mov_b32 s16, -1
    s_mov_b32 s18, s17
    s_branch co_ok32
co_sp37:
    ds_read_b32 v7, v4 offset:2048
    s_add_u32 s46, s46, 1
    s_cmp_gt_u32 s46, 262144
    s_cbranch_scc1 co_ok38
    s_waitcnt lgkmcnt(0)
    v_readfirstlane_b32 s47, v7
    s_nop 0
    s_cmp_lt_u32 s47, 4
    s_cbranch_scc1 co_sp37
    s_branch co_ok38
co_sq40:
    s_mov_b32 s47, 12
co_sp41:
    s_sub_u32 s47, s47, 1
    s_cbranch_scc0 co_ns43
    s_mov_b64 exec, 1
    buffer_store_dwordx2 v[8:9], off, s[48:51], s73 sc1
    s_mov_b64 exec, -1
    s_bitset1_b32 s74, 15
co_ns43:
    buffer_load_dwordx2 v[10:11], v16, s[48:51], s74 offen sc1
    s_waitcnt vmcnt(0)
    s_add_u32 s46, s46, 1
    s_cmp_gt_u32 s46, 262144
    s_cbranch_scc1 co_to42
    v_cmp_eq_u64 vcc, v[10:11], v[8:9]
    v_mov_b32 v12, v10
    v_mov_b32 v13, v11
    s_and_b32 s16, vcc_lo, vcc_hi
    s_and_b32 s18, s16, s17
    s_cbranch_scc0 co_sp41
    s_branch co_ok39
co_to42:
    s_mov_b32 s16, -1
    s_mov_b32 s18, s17
    s_branch co_ok39
co_sq46:
    s_mov_b32 s47, 12
co_sp47:
    s_sub_u32 s47, s47, 1
    s_cbranch_scc0 co_ns49
    s_mov_b64 exec, 1
    buffer_store_dwordx2 v[8:9], off, s[48:51], s73 sc1
    s_mov_b64 exec, -1
    s_bitset1_b32 s74, 15
co_ns49:
    buffer_load_dwordx2 v[10:11], v16, s[48:51], s74 offen sc1
    s_waitcnt vmcnt(0)
    s_add_u32 s46, s46, 1
    s_cmp_gt_u32 s46, 262144
    s_cbranch_scc1 co_to48
    v_cmp_eq_u64 vcc, v[10:11], v[8:9]
    v_mov_b32 v12, v10
    v_mov_b32 v13, v11
    s_and_b32 s16, vcc_lo, vcc_hi
    s_and_b32 s18, s16, s17
    s_cbranch_scc0 co_sp47
    s_branch co_ok45
co_to48:
    s_mov_b32 s16, -1
    s_mov_b32 s18, s17
    s_branch co_ok45
co_sq51:
    s_mov_b32 s47, 12
co_sp52:
    s_sub_u32 s47, s47, 1
    s_cbranch_scc0 co_ns54
    s_mov_b64 exec, 1
    buffer_store_dwordx2 v[8:9], off, s[48:51], s73 sc1
    s_mov_b64 exec, -1
    s_bitset1_b32 s74, 15
co_ns54:
    buffer_load_dwordx2 v[10:11], v16, s[48:51], s74 offen sc1
    s_waitcnt vmcnt(0)
    s_add_u32 s46, s46, 1
    s_cmp_gt_u32 s46, 262144
    s_cbranch_scc1 co_to53
    v_cmp_eq_u64 vcc, v[10:11], v[8:9]
    v_mov_b32 v12, v10
    v_mov_b32 v13, v11
    s_and_b32 s16, vcc_lo, vcc_hi
    s_and_b32 s18, s16, s17
    s_cbranch_scc0 co_sp52
    s_branch co_ok50
co_to53:
    s_mov_b32 s16, -1
    s_mov_b32 s18, s17
    s_branch co_ok50
co_sq56:
    s_mov_b32 s47, 12
co_sp57:
    s_sub_u32 s47, s47, 1
    s_cbranch_scc0 co_ns59
    s_mov_b64 exec, 1
    buffer_store_dwordx2 v[8:9], off, s[48:51], s73 sc1
    s_mov_b64 exec, -1
    s_bitset1_b32 s74, 15
co_ns59:
    buffer_load_dwordx2 v[10:11], v16, s[48:51], s74 offen sc1
    s_waitcnt vmcnt(0)
    s_add_u32 s46, s46, 1
    s_cmp_gt_u32 s46, 262144
    s_cbranch_scc1 co_to58
    v_cmp_eq_u64 vcc, v[10:11], v[8:9]
    v_mov_b32 v12, v10
    v_mov_b32 v13, v11
    s_and_b32 s16, vcc_lo, vcc_hi
    s_and_b32 s18, s16, s17
    s_cbranch_scc0 co_sp57
    s_branch co_ok55
co_to58:
    s_mov_b32 s16, -1
    s_mov_b32 s18, s17
    s_branch co_ok55
co_sq61:
    s_mov_b32 s47, 12
co_sp62:
    s_sub_u32 s47, s47, 1
    s_cbranch_scc0 co_ns64
    s_mov_b64 exec, 1
    buffer_store_dwordx2 v[8:9], off, s[48:51], s73 sc1
    s_mov_b64 exec, -1
    s_bitset1_b32 s74, 15
co_ns64:
    buffer_load_dwordx2 v[10:11], v16, s[48:51], s74 offen sc1
    s_waitcnt vmcnt(0)
    s_add_u32 s46, s46, 1
    s_cmp_gt_u32 s46, 262144
    s_cbranch_scc1 co_to63
    v_cmp_eq_u64 vcc, v[10:11], v[8:9]
    v_mov_b32 v12, v10
    v_mov_b32 v13, v11
    s_and_b32 s16, vcc_lo, vcc_hi
    s_and_b32 s18, s16, s17
    s_cbranch_scc0 co_sp62
    s_branch co_ok60
co_to63:
    s_mov_b32 s16, -1
    s_mov_b32 s18, s17
    s_branch co_ok60
co_sp65:
    ds_read_b32 v7, v4 offset:3072
    s_add_u32 s46, s46, 1
    s_cmp_gt_u32 s46, 262144
    s_cbranch_scc1 co_ok66
    s_waitcnt lgkmcnt(0)
    v_readfirstlane_b32 s47, v7
    s_nop 0
    s_cmp_lt_u32 s47, 4
    s_cbranch_scc1 co_sp65
    s_branch co_ok66
co_sp67:
    ds_read_b32 v7, v4 offset:3328
    s_add_u32 s46, s46, 1
    s_cmp_gt_u32 s46, 262144
    s_cbranch_scc1 co_ok68
    s_waitcnt lgkmcnt(0)
    v_readfirstlane_b32 s47, v7
    s_nop 0
    s_cmp_lt_u32 s47, 4
    s_cbranch_scc1 co_sp67
    s_branch co_ok68
co_sq70:
co_sp71:
    buffer_load_dwordx2 v[10:11], v16, s[48:51], s74 offen sc1
    s_waitcnt vmcnt(0)
    s_add_u32 s46, s46, 1
    s_cmp_gt_u32 s46, 262144
    s_cbranch_scc1 co_ok72
    v_cmp_ne_u64 vcc, v[10:11], v[8:9]
    s_nop 0
    s_cbranch_vccnz co_sp71
    s_branch co_ok72
co_sq73:
co_sp74:
    buffer_load_dwordx2 v[10:11], v16, s[48:51], s74 offen sc1
    s_waitcnt vmcnt(0)
    s_add_u32 s46, s46, 1
    s_cmp_gt_u32 s46, 262144
    s_cbranch_scc1 co_ok75
    v_cmp_ne_u64 vcc, v[10:11], v[8:9]
    s_nop 0
    s_cbranch_vccnz co_sp74
    s_branch co_ok75
co_sq76:
co_sp77:
    buffer_load_dwordx2 v[10:11], v16, s[48:51], s74 offen sc1
    s_waitcnt vmcnt(0)
    s_add_u32 s46, s46, 1
    s_cmp_gt_u32 s46, 262144
    s_cbranch_scc1 co_ok78
    v_cmp_ne_u64 vcc, v[10:11], v[8:9]
    s_nop 0
    s_cbranch_vccnz co_sp77
    s_branch co_ok78
co_sq79:
co_sp80:
    buffer_load_dwordx2 v[10:11], v16, s[48:51], s74 offen sc1
    s_waitcnt vmcnt(0)
    s_add_u32 s46, s46, 1
    s_cmp_gt_u32 s46, 262144
    s_cbranch_scc1 co_ok81
    v_cmp_ne_u64 vcc, v[10:11], v[8:9]
    s_nop 0
    s_cbranch_vccnz co_sp80
    s_branch co_ok81
L_A:
    s_mov_b32 s48, s44
    s_and_b32 s49, s45, 0xffff
    s_mov_b32 s50, 268435456
    s_mov_b32 s51, 0x00020000
    s_mov_b32 s60, s42
    s_and_b32 s61, s43, 0xffff
    s_mov_b32 s62, 256
    s_mov_b32 s63, 0x00020000
    v_lshlrev_b32 v18, 3, v1
    v_and_b32 v2, 1, v1
    v_bfe_u32 v3, v1, 2, 2
    v_lshl_add_u32 v2, v2, 3, v3
    v_sub_u32 v2, 11, v2
    v_lshl_add_u32 v19, v2, 7, s13
    v_and_b32 v2, 0x30, v1
    v_add_u32 v19, v19, v2
    v_and_b32 v2, 2, v1
    v_lshl_add_u32 v19, v2, 2, v19
    v_lshrrev_b32 v2, 3, v1
    v_lshlrev_b32 v2, 14, v2
    v_and_b32 v3, 7, v1
    v_lshl_add_u32 v28, v3, 4, v2
    s_lshl_b32 s66, s4, 18
    s_lshl_b32 s67, s10, 7
    s_add_u32 s66, s66, s67
    s_add_u32 s66, s66, 8388608
    s_add_u32 s67, s66, 0x20000
    s_lshl_b32 s69, s4, 12
    s_add_u32 s69, s69, 14681088
    s_lshl_b32 s68, s10, 3
    s_add_u32 s68, s68, s69
    s_xor_b32 s70, s9, 1
    s_lshl_b32 s71, s70, 9
    s_add_u32 s69, s69, s71
    s_lshl_b32 s73, s70, 11
    s_lshl_b32 s70, s70, 13
    s_lshr_b32 s71, s8, 2
    s_lshl_b32 s71, s71, 14
    s_add_u32 s70, s70, s71
    s_and_b32 s71, s8, 3
    s_lshl_b32 s71, s71, 4
    s_add_u32 s70, s70, s71
    s_add_u32 s70, s70, 8388608
    s_add_u32 s71, s70, 4096
    v_lshlrev_b32 v29, 6, v1
    s_bitcmp1_b32 s8, 0
    s_cselect_b32 s14, 0, 16
    s_waitcnt lgkmcnt(0)
    s_lshl_b32 s64, s64, s14
    s_and_b32 s64, s64, 0xffff0000
    s_lshl_b32 s65, s65, s14
    s_and_b32 s65, s65, 0xffff0000
    s_cmp_eq_u32 s9, 0
    s_cselect_b32 s65, s65, 0
    v_mov_b32 v2, 0x3fb8aa3b
    v_mul_f32 v3, s64, v2
    v_fma_f32 v2, s64, v2, -v3
    v_mov_b32 v32, 0x32a57060
    v_fmac_f32 v2, s64, v32
    v_exp_f32 v3, v3
    v_mul_f32 v2, 0x3f317218, v2
    v_fma_f32 v3, v3, v2, v3
    v_cvt_pk_bf16_f32 v3, v3, v3
    v_and_b32 v30, 0xffff0000, v3
    v_mov_b32 v2, s65
    v_cmp_eq_u32 vcc, 0, v1
    s_nop 1
    v_cndmask_b32 v32, 0, v2, vcc
    v_mov_b32 v33, 0
    v_mov_b32 v34, 0
    v_mov_b32 v35, 0
    v_mul_f32 v48, 0x3fb8aa3b, v30
    v_mul_f32 v49, 0x3e22f983, v30
    v_mul_f32 v50, 0x4138aa3b, v30
    v_mul_f32 v51, 0x3fa2f983, v30
    v_mul_f32 v52, 0x43b8aa3b, v30
    v_mul_f32 v53, 0x4222f983, v30
    v_lshrrev_b32 v2, 1, v1
    v_xor_b32 v3, v2, v1
    v_and_b32 v2, 7, v2
    v_and_or_b32 v2, v3, 16, v2
    v_and_b32 v3, 1, v1
    v_lshlrev_b32 v3, 4, v3
    v_mov_b32 v63, 0x3f80
    v_lshlrev_b32 v3, v3, v63
    v_cmp_eq_u32 vcc, 0, v2
    s_nop 1
    v_cndmask_b32 v56, 0, v3, vcc
    v_cmp_eq_u32 vcc, 1, v2
    s_nop 1
    v_cndmask_b32 v57, 0, v3, vcc
    v_cmp_eq_u32 vcc, 2, v2
    s_nop 1
    v_cndmask_b32 v58, 0, v3, vcc
    v_cmp_eq_u32 vcc, 3, v2
    s_nop 1
    v_cndmask_b32 v59, 0, v3, vcc
    v_cmp_eq_u32 vcc, 4, v2
    s_nop 1
    v_cndmask_b32 v60, 0, v3, vcc
    v_cmp_eq_u32 vcc, 5, v2
    s_nop 1
    v_cndmask_b32 v61, 0, v3, vcc
    v_cmp_eq_u32 vcc, 6, v2
    s_nop 1
    v_cndmask_b32 v62, 0, v3, vcc
    v_cmp_eq_u32 vcc, 7, v2
    s_nop 1
    v_cndmask_b32 v63, 0, v3, vcc
    v_lshrrev_b32 v2, 4, v1
    v_lshlrev_b32 v3, 2, v2
    v_mul_u32_u24 v2, 896, v2
    v_xor_b32 v3, v3, v1
    v_and_b32 v3, 15, v3
    v_min_u32 v3, 13, v3
    v_lshl_add_u32 v247, v3, 4, v2
    s_and_b32 s14, s5, 3
    s_mul_i32 s14, s14, 224
    s_mul_i32 s24, s3, 100352
    s_add_u32 s24, s24, s14
    s_mul_i32 s25, s3, 28672
    s_lshl_b32 s29, s6, 2
    s_add_u32 s29, s29, s3
    s_lshl_b32 s29, s29, 4
    s_add_u32 s29, s29, s75
    s_lshl_b32 s29, s29, 11
    s_add_u32 s29, s29, 6291456
    s_mul_i32 s14, s3, 56
    v_bfe_u32 v2, v1, 4, 1
    v_lshl_add_u32 v251, v2, 5, s14
    v_and_b32 v2, 3, v1
    v_lshl_add_u32 v251, v2, 3, v251
    v_bfe_u32 v2, v1, 2, 2
    v_lshrrev_b32 v3, 5, v1
    v_lshl_add_u32 v248, v3, 2, v2
    v_mad_u32_u24 v249, v3, 3, v2
    v_add_u32 v250, 6, v249
    v_and_b32 v2, 3, v248
    v_lshlrev_b32 v2, 6, v2
    v_xor_b32 v2, v2, v251
    v_lshl_add_u32 v248, v248, 8, v2
    v_and_b32 v2, 3, v249
    v_lshlrev_b32 v2, 6, v2
    v_xor_b32 v2, v2, v251
    v_lshl_add_u32 v249, v249, 8, v2
    v_and_b32 v2, 3, v250
    v_lshlrev_b32 v2, 6, v2
    v_xor_b32 v2, v2, v251
    v_lshl_add_u32 v250, v250, 8, v2
    v_add_u32 v251, 57344, v248
    v_add_u32 v252, 57344, v249
    v_add_u32 v253, 57344, v250
    s_lshr_b32 s14, s10, 6
    s_lshl_b32 s14, s14, 9
    s_lshl_b32 s15, s4, 12
    s_add_u32 s14, s14, s15
    s_add_u32 s18, s14, 14682112
    v_lshrrev_b32 v2, 1, v1
    v_lshlrev_b32 v2, 12, v2
    v_and_b32 v3, 1, v1
    v_lshl_add_u32 v244, v3, 4, v2
    s_lshl_b32 s15, s4, 18
    s_lshl_b32 s14, s10, 5
    s_add_u32 s15, s15, s14
    s_add_u32 s19, s15, 12582912
    s_add_u32 s20, s19, 0x20000
    s_lshl_b32 s21, s3, 11
    s_add_u32 s21, s21, 122880
    v_bfe_u32 v2, v1, 4, 1
    v_lshlrev_b32 v2, 2, v2
    v_and_or_b32 v2, v1, 3, v2
    v_lshl_add_u32 v245, v2, 8, s21
    v_bfe_u32 v2, v1, 2, 2
    v_lshl_add_u32 v245, v2, 5, v245
    v_lshrrev_b32 v2, 5, v1
    v_lshl_add_u32 v245, v2, 3, v245
    v_lshlrev_b32 v2, 2, v2
    v_and_or_b32 v2, v1, 3, v2
    v_mul_u32_u24 v2, 1792, v2
    v_bfe_u32 v3, v1, 2, 3
    v_lshl_add_u32 v246, v3, 4, v2
    s_mul_i32 s22, s10, 28672
    s_lshl_b32 s15, s4, 7
    s_add_u32 s22, s22, s15
    s_add_u32 s23, s22, 14336
    s_mov_b32 s56, s40
    s_and_b32 s57, s41, 0xffff
    s_mov_b32 s58, 3670016
    s_mov_b32 s59, 0x00020000
    v_lshrrev_b32 v3, 4, v1
    v_and_b32 v2, 15, v1
    v_lshlrev_b32 v229, 4, v3
    v_lshl_add_u32 v229, v2, 7, v229
    v_add_u32 v229, s13, v229
    v_max_u32 v55, 1, v3
    v_sub_u32 v55, 6, v55
    v_lshlrev_b32 v228, 3, v3
    v_mov_b32 v54, 0x60400100
    v_bfe_u32 v228, v54, v228, 8
    v_lshl_add_u32 v228, v228, 4, s13
    v_lshl_add_u32 v31, v2, v55, v228
    v_lshl_add_u32 v54, 16, v55, v31
    v_cmp_eq_u32 vcc, 3, v3
    s_nop 1
    v_cndmask_b32 v228, 1, 32, vcc
    v_lshl_add_u32 v55, v228, 3, v31
    v_lshl_add_u32 v228, v228, 3, v54
    s_lshl_b32 s14, s12, 8
    v_add_u32 v236, s14, v4
    s_lshl_b32 s14, s9, 6
    v_add_u32 v233, s14, v1
    v_lshl_add_u32 v230, v233, 2, s72
    v_add_u32 v231, 4, v230
    v_lshl_add_u32 v232, v233, 3, s72
    v_lshl_add_u32 v233, v233, 4, s72
    v_lshrrev_b32 v3, 4, v1
    v_and_b32 v2, 15, v1
    v_lshlrev_b32 v235, 5, v2
    s_lshl_b32 s14, s9, 8
    s_sub_u32 s14, s72, s14
    v_lshl_add_u32 v234, v3, 4, s14
    v_bfe_u32 v2, v1, 1, 3
    v_lshlrev_b32 v2, 2, v2
    v_sub_u32 v240, v234, v2
    v_add_u32 v234, v234, v235
    v_lshl_add_u32 v235, v3, 3, v235
    v_and_b32 v2, 1, v1
    v_mul_u32_u24 v2, 4160, v2
    v_sub_u32 v240, v240, v2
    v_add_u32 v243, 17244, v240
    v_add_u32 v242, 18268, v240
    v_add_u32 v241, 19292, v240
    v_add_u32 v240, 20316, v240
    s_add_u32 s14, s72, s73
    v_add_u32 v237, s14, v5
    v_add_u32 v238, s13, v5
    s_add_u32 s14, s14, s73
    v_add_u32 v239, s14, v5
    s_waitcnt vmcnt(6)
    ds_read_b64_tr_b16 v[20:21], v19 offset:512
    ds_read_b64_tr_b16 v[22:23], v19 offset:0
    ds_read_b64_tr_b16 v[24:25], v19 offset:576
    ds_read_b64_tr_b16 v[26:27], v19 offset:64
    s_setprio 0
    s_waitcnt vmcnt(5)
    v_lshlrev_b32 v184, 16, v12
    s_waitcnt vmcnt(4)
    v_lshlrev_b32 v185, 16, v13
    s_waitcnt vmcnt(3)
    v_lshlrev_b32 v186, 16, v14
    s_waitcnt vmcnt(2)
    v_lshlrev_b32 v187, 16, v15
    s_waitcnt vmcnt(1)
    v_lshlrev_b32 v188, 16, v16
    s_waitcnt vmcnt(0)
    v_lshlrev_b32 v189, 16, v17
    v_mul_f32 v213, v185, v49
    v_mul_f32 v212, v184, v48
    v_mul_f32 v215, v185, v51
    v_mul_f32 v214, v184, v50
    v_mul_f32 v217, v185, v53
    v_mul_f32 v216, v184, v52
    v_mul_f32 v186, v186, v30
    v_mul_f32 v187, v187, v30
    v_fract_f32 v213, v213
    v_fract_f32 v215, v215
    v_fract_f32 v217, v217
    v_exp_f32 v212, v212
    v_cos_f32 v190, v213
    v_sin_f32 v191, v213
    v_exp_f32 v214, v214
    v_cos_f32 v200, v215
    v_sin_f32 v201, v215
    v_exp_f32 v216, v216
    v_cos_f32 v204, v217
    v_sin_f32 v205, v217
    v_mul_f32 v218, v188, v186
    v_mul_f32 v219, v188, v187
    v_fma_f32 v218, -v189, v187, v218
    v_fmac_f32 v219, v189, v186
    v_mul_f32 v190, v190, v212
    v_mul_f32 v191, v191, v212
    v_mul_f32 v200, v200, v214
    v_mul_f32 v201, v201, v214
    v_mul_f32 v204, v204, v216
    v_mul_f32 v205, v205, v216
    v_mul_f32 v192, v190, v190
    v_mul_f32 v206, v204, v204
    v_mul_f32 v202, v200, v200
    v_mul_f32 v222, v218, v200
    s_waitcnt lgkmcnt(2)
    buffer_store_dwordx4 v[20:23], v28, s[48:51], s66 offen sc1
    s_waitcnt lgkmcnt(0)
    buffer_store_dwordx4 v[24:27], v28, s[48:51], s67 offen sc1
    buffer_load_dwordx2 v[8:9], off, s[60:63], 0 sc1
    v_mul_f32 v193, v190, v191
    v_mul_f32 v207, v204, v205
    s_cmp_lg_u32 s3, 0
    s_cbranch_scc1 co_pf82
    s_lshr_b32 s14, s75, 1
    s_lshr_b32 s15, s2, 3
    s_cmp_lt_u32 s15, 8
    s_cselect_b32 s14, s14, s4
    s_cselect_b32 s15, s15, s5
    s_lshl_b32 s14, s14, 5
    s_add_u32 s14, s14, s15
    s_lshl_b32 s14, s14, 7
    s_add_u32 s14, s14, 14680064
    s_mov_b64 exec, 1
    buffer_load_dword v10, off, s[48:51], s14 sc1
    s_mov_b64 exec, -1
co_pf82:
    v_mul_f32 v203, v200, v201
    v_mul_f32 v223, v218, v201
    v_fma_f32 v192, -v191, v191, v192
    v_fma_f32 v206, -v205, v205, v206
    v_fma_f32 v202, -v201, v201, v202
    v_fma_f32 v222, -v219, v201, v222
    v_fmac_f32 v193, v191, v190
    v_fmac_f32 v207, v205, v204
    v_fmac_f32 v203, v201, v200
    v_fmac_f32 v223, v219, v200
    v_cvt_pk_bf16_f32 v160, 1.0, v190
    v_cvt_pk_bf16_f32 v164, 0, -v191
    v_mul_f32 v194, v192, v190
    v_mul_f32 v196, v192, v192
    v_mul_f32 v208, v206, v204
    v_mul_f32 v210, v206, v206
    v_mul_f32 v195, v192, v191
    v_mul_f32 v197, v192, v193
    v_mul_f32 v209, v206, v205
    v_mul_f32 v211, v206, v207
    v_fma_f32 v194, -v193, v191, v194
    v_fma_f32 v196, -v193, v193, v196
    v_fma_f32 v208, -v207, v205, v208
    v_fma_f32 v210, -v207, v207, v210
    v_fmac_f32 v195, v193, v190
    v_fmac_f32 v197, v193, v192
    v_fmac_f32 v209, v207, v204
    v_fmac_f32 v211, v207, v206
    v_cvt_pk_bf16_f32 v161, v192, v194
    v_cvt_pk_bf16_f32 v165, -v193, -v195
    v_mul_f32 v212, v196, v190
    v_mul_f32 v198, v196, v192
    v_mul_f32 v214, v196, v194
    v_mul_f32 v216, v204, v192
    v_mul_f32 v213, v196, v191
    v_mul_f32 v199, v196, v193
    v_mul_f32 v215, v196, v195
    v_mul_f32 v217, v204, v193
    v_fma_f32 v212, -v197, v191, v212
    v_fma_f32 v198, -v197, v193, v198
    v_fma_f32 v214, -v197, v195, v214
    v_fma_f32 v216, -v205, v193, v216
    v_fmac_f32 v213, v197, v190
    v_fmac_f32 v199, v197, v192
    v_fmac_f32 v215, v197, v194
    v_fmac_f32 v217, v205, v192
    v_cvt_pk_bf16_f32 v162, v196, v212
    v_cvt_pk_bf16_f32 v166, -v197, -v213
    v_cvt_pk_bf16_f32 v163, v198, v214
    v_cvt_pk_bf16_f32 v167, -v199, -v215
    v_cvt_pk_bf16_f32 v168, v204, v216
    v_mfma_f32_32x32x16_bf16 v[64:79], v[160:163], v[56:59], 0
    v_cvt_pk_bf16_f32 v172, -v205, -v217
    v_mul_f32 v212, v204, v196
    v_mul_f32 v214, v204, v198
    v_mul_f32 v216, v206, v196
    v_mul_f32 v194, v208, v196
    v_mfma_f32_32x32x16_bf16 v[80:95], v[164:167], v[56:59], 0
    v_mul_f32 v213, v204, v197
    v_mul_f32 v215, v204, v199
    v_mul_f32 v217, v206, v197
    v_mul_f32 v195, v208, v197
    v_fma_f32 v212, -v205, v197, v212
    v_fma_f32 v214, -v205, v199, v214
    v_fma_f32 v216, -v207, v197, v216
    v_fma_f32 v194, -v209, v197, v194
    v_fmac_f32 v213, v205, v196
    v_fmac_f32 v215, v205, v198
    v_fmac_f32 v217, v207, v196
    v_fmac_f32 v195, v209, v196
    v_cvt_pk_bf16_f32 v169, v212, v214
    v_cvt_pk_bf16_f32 v173, -v213, -v215
    v_cvt_pk_bf16_f32 v170, v206, v216
    v_cvt_pk_bf16_f32 v174, -v207, -v217
    v_cvt_pk_bf16_f32 v171, v208, v194
    v_cvt_pk_bf16_f32 v175, -v209, -v195
    v_mul_f32 v212, v210, v204
    v_mfma_f32_32x32x16_bf16 v[64:79], v[168:171], v[60:63], v[64:79]
    v_mul_f32 v214, v210, v206
    v_mul_f32 v216, v210, v208
    v_mul_f32 v194, v210, v210
    v_mul_f32 v213, v210, v205
    v_mul_f32 v215, v210, v207
    v_mfma_f32_32x32x16_bf16 v[80:95], v[172:175], v[60:63], v[80:95]
    v_mul_f32 v217, v210, v209
    v_mul_f32 v195, v210, v211
    v_fma_f32 v212, -v211, v205, v212
    v_fma_f32 v214, -v211, v207, v214
    v_fma_f32 v216, -v211, v209, v216
    v_fma_f32 v194, -v211, v211, v194
    v_fmac_f32 v213, v211, v204
    v_fmac_f32 v215, v211, v206
    v_fmac_f32 v217, v211, v208
    v_fmac_f32 v195, v211, v210
    v_cvt_pk_bf16_f32 v176, v210, v212
    v_cvt_pk_bf16_f32 v180, -v211, -v213
    v_cvt_pk_bf16_f32 v177, v214, v216
    v_cvt_pk_bf16_f32 v181, -v215, -v217
    v_cvt_pk_bf16_f32 v178, v194, 0
    v_cvt_pk_bf16_f32 v182, -v195, 0
    v_mov_b32 v179, 0
    v_mov_b32 v183, 0
    v_xor_b32 v226, 0x80000000, v203
    v_mfma_f32_32x32x16_bf16 v[96:111], v[176:179], v[56:59], 0
    v_mul_f32 v220, v218, v202
    v_mul_f32 v224, v222, v202
    v_mul_f32 v221, v218, v203
    v_mul_f32 v225, v222, v203
    v_fmac_f32 v220, v219, v226
    v_mfma_f32_32x32x16_bf16 v[112:127], v[180:183], v[56:59], 0
    v_fmac_f32 v224, v223, v226
    v_fmac_f32 v221, v219, v202
    v_fmac_f32 v225, v223, v202
    v_cvt_pk_bf16_f32 v160, v218, v222
    v_cvt_pk_bf16_f32 v164, v219, v223
    v_mul_f32 v218, v220, v202
    v_mul_f32 v222, v224, v202
    v_mul_f32 v219, v220, v203
    v_mul_f32 v223, v224, v203
    v_fmac_f32 v218, v221, v226
    v_fmac_f32 v222, v225, v226
    v_fmac_f32 v219, v221, v202
    v_fmac_f32 v223, v225, v202
    v_cvt_pk_bf16_f32 v161, v220, v224
    v_cvt_pk_bf16_f32 v165, v221, v225
    v_mul_f32 v220, v218, v202
    v_mul_f32 v224, v222, v202
    v_mul_f32 v221, v218, v203
    v_mul_f32 v225, v222, v203
    v_fmac_f32 v220, v219, v226
    v_fmac_f32 v224, v223, v226
    v_fmac_f32 v221, v219, v202
    v_fmac_f32 v225, v223, v202
    v_cvt_pk_bf16_f32 v162, v218, v222
    v_cvt_pk_bf16_f32 v166, v219, v223
    v_mul_f32 v218, v220, v202
    v_mul_f32 v222, v224, v202
    v_mul_f32 v219, v220, v203
    v_mul_f32 v223, v224, v203
    v_fmac_f32 v218, v221, v226
    v_fmac_f32 v222, v225, v226
    v_fmac_f32 v219, v221, v202
    v_fmac_f32 v223, v225, v202
    v_cvt_pk_bf16_f32 v163, v220, v224
    v_cvt_pk_bf16_f32 v167, v221, v225
    v_mul_f32 v220, v218, v202
    v_mfma_f32_32x32x16_bf16 v[128:143], v[160:163], v[56:59], 0
    v_mul_f32 v224, v222, v202
    v_mul_f32 v221, v218, v203
    v_mul_f32 v225, v222, v203
    v_fmac_f32 v220, v219, v226
    v_fmac_f32 v224, v223, v226
    v_mfma_f32_32x32x16_bf16 v[144:159], v[164:167], v[56:59], 0
    v_fmac_f32 v221, v219, v202
    v_fmac_f32 v225, v223, v202
    v_cvt_pk_bf16_f32 v168, v218, v222
    v_cvt_pk_bf16_f32 v172, v219, v223
    v_mul_f32 v218, v220, v202
    v_mul_f32 v222, v224, v202
    v_mul_f32 v219, v220, v203
    v_mul_f32 v223, v224, v203
    v_fmac_f32 v218, v221, v226
    v_fmac_f32 v222, v225, v226
    v_fmac_f32 v219, v221, v202
    v_fmac_f32 v223, v225, v202
    v_cvt_pk_bf16_f32 v169, v220, v224
    v_cvt_pk_bf16_f32 v173, v221, v225
    v_mul_f32 v220, v218, v202
    v_mul_f32 v224, v222, v202
    v_mul_f32 v221, v218, v203
    v_mul_f32 v225, v222, v203
    v_fmac_f32 v220, v219, v226
    v_fmac_f32 v224, v223, v226
    v_fmac_f32 v221, v219, v202
    v_fmac_f32 v225, v223, v202
    v_cvt_pk_bf16_f32 v170, v218, v222
    v_cvt_pk_bf16_f32 v174, v219, v223
    v_mul_f32 v218, v220, v202
    v_mul_f32 v222, v224, v202
    v_mul_f32 v219, v220, v203
    v_mul_f32 v223, v224, v203
    v_fmac_f32 v218, v221, v226
    v_fmac_f32 v222, v225, v226
    v_fmac_f32 v219, v221, v202
    v_fmac_f32 v223, v225, v202
    v_cvt_pk_bf16_f32 v171, v220, v224
    v_cvt_pk_bf16_f32 v175, v221, v225
    v_mul_f32 v220, v218, v202
    v_mfma_f32_32x32x16_bf16 v[128:143], v[168:171], v[60:63], v[128:143]
    v_mul_f32 v224, v222, v202
    v_mul_f32 v221, v218, v203
    v_mul_f32 v225, v222, v203
    v_fmac_f32 v220, v219, v226
    v_fmac_f32 v224, v223, v226
    v_mfma_f32_32x32x16_bf16 v[144:159], v[172:175], v[60:63], v[144:159]
    v_fmac_f32 v221, v219, v202
    v_fmac_f32 v225, v223, v202
    v_cvt_pk_bf16_f32 v176, v218, v222
    v_cvt_pk_bf16_f32 v180, v219, v223
    v_mul_f32 v218, v220, v202
    v_mul_f32 v222, v224, v202
    v_mfma_f32_16x16x32_bf16 v[32:35], v[64:67], v[128:131], v[32:35]
    v_mul_f32 v219, v220, v203
    v_mul_f32 v223, v224, v203
    v_mfma_f32_16x16x32_bf16 v[40:43], v[128:131], v[96:99], 0
    v_fmac_f32 v218, v221, v226
    v_fmac_f32 v222, v225, v226
    v_mfma_f32_16x16x32_bf16 v[32:35], v[68:71], v[132:135], v[32:35]
    v_fmac_f32 v219, v221, v202
    v_fmac_f32 v223, v225, v202
    v_mfma_f32_16x16x32_bf16 v[40:43], v[132:135], v[100:103], v[40:43]
    v_cvt_pk_bf16_f32 v177, v220, v224
    v_cvt_pk_bf16_f32 v181, v221, v225
    v_mfma_f32_16x16x32_bf16 v[32:35], v[72:75], v[136:139], v[32:35]
    v_mul_f32 v220, v218, v202
    v_mul_f32 v224, v222, v202
    v_mfma_f32_16x16x32_bf16 v[40:43], v[136:139], v[104:107], v[40:43]
    v_mul_f32 v221, v218, v203
    v_mul_f32 v225, v222, v203
    v_mfma_f32_16x16x32_bf16 v[32:35], v[76:79], v[140:143], v[32:35]
    v_fmac_f32 v220, v219, v226
    v_fmac_f32 v224, v223, v226
    v_mfma_f32_16x16x32_bf16 v[40:43], v[140:143], v[108:111], v[40:43]
    v_fmac_f32 v221, v219, v202
    v_fmac_f32 v225, v223, v202
    v_mfma_f32_16x16x32_bf16 v[32:35], v[80:83], v[144:147], v[32:35]
    v_cvt_pk_bf16_f32 v178, v218, v222
    v_cvt_pk_bf16_f32 v182, v219, v223
    v_mfma_f32_16x16x32_bf16 v[40:43], v[144:147], v[112:115], v[40:43]
    s_waitcnt vmcnt(0)
    v_cmp_eq_u32 vcc, 0, v8
    s_nop 0
    s_cbranch_vccnz co_sp83
co_ok84:
    s_mov_b64 exec, 1
    buffer_store_dwordx2 v[8:9], off, s[48:51], s68
    s_bitset1_b32 s68, 15
    buffer_store_dwordx2 v[8:9], off, s[48:51], s68 sc1
    s_mov_b64 exec, -1
    v_mul_f32 v218, v220, v202
    v_mul_f32 v222, v224, v202
    v_mfma_f32_16x16x32_bf16 v[32:35], v[84:87], v[148:151], v[32:35]
    v_mul_f32 v219, v220, v203
    v_mul_f32 v223, v224, v203
    v_mfma_f32_16x16x32_bf16 v[40:43], v[148:151], v[116:119], v[40:43]
    v_fmac_f32 v218, v221, v226
    v_fmac_f32 v222, v225, v226
    v_mfma_f32_16x16x32_bf16 v[32:35], v[88:91], v[152:155], v[32:35]
    v_fmac_f32 v219, v221, v202
    v_fmac_f32 v223, v225, v202
    v_mfma_f32_16x16x32_bf16 v[40:43], v[152:155], v[120:123], v[40:43]
    v_cvt_pk_bf16_f32 v179, v220, v224
    v_cvt_pk_bf16_f32 v183, v221, v225
    v_mfma_f32_16x16x32_bf16 v[32:35], v[92:95], v[156:159], v[32:35]
    v_mul_f32 v220, v218, v202
    v_mul_f32 v224, v222, v202
    v_mfma_f32_16x16x32_bf16 v[40:43], v[156:159], v[124:127], v[40:43]
    v_mul_f32 v221, v218, v203
    v_mul_f32 v225, v222, v203
    v_mfma_f32_32x32x16_bf16 v[128:143], v[176:179], v[56:59], 0
    v_fmac_f32 v220, v219, v226
    v_fmac_f32 v224, v223, v226
    v_fmac_f32 v221, v219, v202
    v_fmac_f32 v225, v223, v202
    v_cvt_pk_bf16_f32 v160, v218, v222
    v_mfma_f32_32x32x16_bf16 v[144:159], v[180:183], v[56:59], 0
    v_cvt_pk_bf16_f32 v164, v219, v223
    v_mul_f32 v218, v220, v202
    v_mul_f32 v222, v224, v202
    v_mul_f32 v219, v220, v203
    v_mul_f32 v223, v224, v203
    v_fmac_f32 v218, v221, v226
    v_fmac_f32 v222, v225, v226
    v_fmac_f32 v219, v221, v202
    v_fmac_f32 v223, v225, v202
    v_cvt_pk_bf16_f32 v161, v220, v224
    v_cvt_pk_bf16_f32 v165, v221, v225
    v_mul_f32 v220, v218, v202
    v_mul_f32 v224, v222, v202
    v_mul_f32 v221, v218, v203
    v_mul_f32 v225, v222, v203
    v_fmac_f32 v220, v219, v226
    v_fmac_f32 v224, v223, v226
    v_fmac_f32 v221, v219, v202
    v_fmac_f32 v225, v223, v202
    v_cvt_pk_bf16_f32 v162, v218, v222
    v_cvt_pk_bf16_f32 v166, v219, v223
    v_cvt_pk_bf16_f32 v163, v220, v224
    v_cvt_pk_bf16_f32 v167, v221, v225
    v_and_b32 v184, 0xffff0000, v12
    v_mfma_f32_32x32x16_bf16 v[128:143], v[160:163], v[60:63], v[128:143]
    v_and_b32 v185, 0xffff0000, v13
    v_and_b32 v186, 0xffff0000, v14
    v_and_b32 v187, 0xffff0000, v15
    v_and_b32 v188, 0xffff0000, v16
    v_and_b32 v189, 0xffff0000, v17
    v_mfma_f32_32x32x16_bf16 v[144:159], v[164:167], v[60:63], v[144:159]
    v_mul_f32 v213, v185, v49
    v_mul_f32 v212, v184, v48
    v_mul_f32 v215, v185, v51
    v_mul_f32 v214, v184, v50
    v_mul_f32 v217, v185, v53
    v_mul_f32 v216, v184, v52
    v_mfma_f32_16x16x32_bf16 v[36:39], v[64:67], v[128:131], 0
    v_mul_f32 v186, v186, v30
    v_mul_f32 v187, v187, v30
    v_mfma_f32_16x16x32_bf16 v[44:47], v[128:131], v[96:99], 0
    v_fract_f32 v213, v213
    v_fract_f32 v215, v215
    v_mfma_f32_16x16x32_bf16 v[36:39], v[68:71], v[132:135], v[36:39]
    v_fract_f32 v217, v217
    v_exp_f32 v212, v212
    v_mfma_f32_16x16x32_bf16 v[44:47], v[132:135], v[100:103], v[44:47]
    v_cos_f32 v190, v213
    v_sin_f32 v191, v213
    v_mfma_f32_16x16x32_bf16 v[36:39], v[72:75], v[136:139], v[36:39]
    v_exp_f32 v214, v214
    v_cos_f32 v200, v215
    v_mfma_f32_16x16x32_bf16 v[44:47], v[136:139], v[104:107], v[44:47]
    v_sin_f32 v201, v215
    v_exp_f32 v216, v216
    v_mfma_f32_16x16x32_bf16 v[36:39], v[76:79], v[140:143], v[36:39]
    v_cos_f32 v204, v217
    v_sin_f32 v205, v217
    v_mfma_f32_16x16x32_bf16 v[44:47], v[140:143], v[108:111], v[44:47]
    v_mul_f32 v218, v188, v186
    v_mul_f32 v219, v188, v187
    v_mfma_f32_16x16x32_bf16 v[36:39], v[80:83], v[144:147], v[36:39]
    v_fma_f32 v218, -v189, v187, v218
    v_fmac_f32 v219, v189, v186
    v_mfma_f32_16x16x32_bf16 v[44:47], v[144:147], v[112:115], v[44:47]
    v_mul_f32 v190, v190, v212
    v_mul_f32 v191, v191, v212
    v_mfma_f32_16x16x32_bf16 v[36:39], v[84:87], v[148:151], v[36:39]
    v_mul_f32 v200, v200, v214
    v_mul_f32 v201, v201, v214
    v_mfma_f32_16x16x32_bf16 v[44:47], v[148:151], v[116:119], v[44:47]
    v_mul_f32 v204, v204, v216
    v_mul_f32 v205, v205, v216
    v_mfma_f32_16x16x32_bf16 v[36:39], v[88:91], v[152:155], v[36:39]
    v_mul_f32 v192, v190, v190
    v_mul_f32 v206, v204, v204
    v_mfma_f32_16x16x32_bf16 v[44:47], v[152:155], v[120:123], v[44:47]
    v_mul_f32 v202, v200, v200
    v_mul_f32 v222, v218, v200
    v_mfma_f32_16x16x32_bf16 v[36:39], v[92:95], v[156:159], v[36:39]
    v_mul_f32 v193, v190, v191
    v_mul_f32 v207, v204, v205
    v_mfma_f32_16x16x32_bf16 v[44:47], v[156:159], v[124:127], v[44:47]
    v_mul_f32 v203, v200, v201
    v_mul_f32 v223, v218, v201
    v_fma_f32 v192, -v191, v191, v192
    v_fma_f32 v206, -v205, v205, v206
    v_fma_f32 v202, -v201, v201, v202
    v_fma_f32 v222, -v219, v201, v222
    v_fmac_f32 v193, v191, v190
    v_fmac_f32 v207, v205, v204
    v_fmac_f32 v203, v201, v200
    v_fmac_f32 v223, v219, v200
    v_cvt_pk_bf16_f32 v168, 1.0, v190
    v_cvt_pk_bf16_f32 v172, 0, -v191
    v_mul_f32 v194, v192, v190
    v_mul_f32 v196, v192, v192
    v_mul_f32 v208, v206, v204
    v_mul_f32 v210, v206, v206
    v_mul_f32 v195, v192, v191
    v_mul_f32 v197, v192, v193
    v_mul_f32 v209, v206, v205
    v_mul_f32 v211, v206, v207
    v_fma_f32 v194, -v193, v191, v194
    v_fma_f32 v196, -v193, v193, v196
    v_fma_f32 v208, -v207, v205, v208
    v_fma_f32 v210, -v207, v207, v210
    v_fmac_f32 v195, v193, v190
    v_fmac_f32 v197, v193, v192
    v_fmac_f32 v209, v207, v204
    v_fmac_f32 v211, v207, v206
    v_cvt_pk_bf16_f32 v169, v192, v194
    v_cvt_pk_bf16_f32 v173, -v193, -v195
    v_mul_f32 v212, v196, v190
    v_mul_f32 v198, v196, v192
    v_mul_f32 v214, v196, v194
    v_mul_f32 v216, v204, v192
    v_mul_f32 v213, v196, v191
    v_mul_f32 v199, v196, v193
    v_mul_f32 v215, v196, v195
    v_mul_f32 v217, v204, v193
    v_fma_f32 v212, -v197, v191, v212
    v_fma_f32 v198, -v197, v193, v198
    v_fma_f32 v214, -v197, v195, v214
    v_fma_f32 v216, -v205, v193, v216
    v_fmac_f32 v213, v197, v190
    v_fmac_f32 v199, v197, v192
    v_fmac_f32 v215, v197, v194
    v_fmac_f32 v217, v205, v192
    v_cvt_pk_bf16_f32 v170, v196, v212
    v_cvt_pk_bf16_f32 v174, -v197, -v213
    v_cvt_pk_bf16_f32 v171, v198, v214
    v_cvt_pk_bf16_f32 v175, -v199, -v215
    v_cvt_pk_bf16_f32 v176, v204, v216
    v_mfma_f32_32x32x16_bf16 v[64:79], v[168:171], v[56:59], 0
    v_cvt_pk_bf16_f32 v180, -v205, -v217
    v_mul_f32 v212, v204, v196
    v_mul_f32 v214, v204, v198
    v_mul_f32 v216, v206, v196
    v_mul_f32 v194, v208, v196
    v_mfma_f32_32x32x16_bf16 v[80:95], v[172:175], v[56:59], 0
    v_mul_f32 v213, v204, v197
    v_mul_f32 v215, v204, v199
    v_mul_f32 v217, v206, v197
    v_mul_f32 v195, v208, v197
    v_fma_f32 v212, -v205, v197, v212
    v_fma_f32 v214, -v205, v199, v214
    v_fma_f32 v216, -v207, v197, v216
    v_fma_f32 v194, -v209, v197, v194
    v_fmac_f32 v213, v205, v196
    v_fmac_f32 v215, v205, v198
    v_fmac_f32 v217, v207, v196
    v_fmac_f32 v195, v209, v196
    v_cvt_pk_bf16_f32 v177, v212, v214
    v_cvt_pk_bf16_f32 v181, -v213, -v215
    v_cvt_pk_bf16_f32 v178, v206, v216
    v_cvt_pk_bf16_f32 v182, -v207, -v217
    v_cvt_pk_bf16_f32 v179, v208, v194
    v_cvt_pk_bf16_f32 v183, -v209, -v195
    v_mul_f32 v212, v210, v204
    v_mfma_f32_32x32x16_bf16 v[64:79], v[176:179], v[60:63], v[64:79]
    v_mul_f32 v214, v210, v206
    v_mul_f32 v216, v210, v208
    v_mul_f32 v194, v210, v210
    v_mul_f32 v213, v210, v205
    v_mul_f32 v215, v210, v207
    v_mfma_f32_32x32x16_bf16 v[80:95], v[180:183], v[60:63], v[80:95]
    v_mul_f32 v217, v210, v209
    v_mul_f32 v195, v210, v211
    v_fma_f32 v212, -v211, v205, v212
    v_fma_f32 v214, -v211, v207, v214
    v_fma_f32 v216, -v211, v209, v216
    v_fma_f32 v194, -v211, v211, v194
    v_fmac_f32 v213, v211, v204
    v_fmac_f32 v215, v211, v206
    v_fmac_f32 v217, v211, v208
    buffer_load_dwordx2 v[10:11], v18, s[48:51], s69 offen sc1
    v_fmac_f32 v195, v211, v210
    v_cvt_pk_bf16_f32 v160, v210, v212
    v_cvt_pk_bf16_f32 v164, -v211, -v213
    v_cvt_pk_bf16_f32 v161, v214, v216
    v_cvt_pk_bf16_f32 v165, -v215, -v217
    v_cvt_pk_bf16_f32 v162, v194, 0
    v_cvt_pk_bf16_f32 v166, -v195, 0
    v_mov_b32 v163, 0
    v_mov_b32 v167, 0
    v_xor_b32 v226, 0x80000000, v203
    v_mfma_f32_32x32x16_bf16 v[96:111], v[160:163], v[56:59], 0
    v_mul_f32 v220, v218, v202
    v_mul_f32 v224, v222, v202
    v_mul_f32 v221, v218, v203
    v_mul_f32 v225, v222, v203
    v_fmac_f32 v220, v219, v226
    v_mfma_f32_32x32x16_bf16 v[112:127], v[164:167], v[56:59], 0
    v_fmac_f32 v224, v223, v226
    v_fmac_f32 v221, v219, v202
    v_fmac_f32 v225, v223, v202
    v_cvt_pk_bf16_f32 v168, v218, v222
    v_cvt_pk_bf16_f32 v172, v219, v223
    v_mul_f32 v218, v220, v202
    v_mul_f32 v222, v224, v202
    v_mul_f32 v219, v220, v203
    v_mul_f32 v223, v224, v203
    v_fmac_f32 v218, v221, v226
    v_fmac_f32 v222, v225, v226
    v_fmac_f32 v219, v221, v202
    v_fmac_f32 v223, v225, v202
    v_cvt_pk_bf16_f32 v169, v220, v224
    v_cvt_pk_bf16_f32 v173, v221, v225
    v_mul_f32 v220, v218, v202
    v_mul_f32 v224, v222, v202
    v_mul_f32 v221, v218, v203
    v_mul_f32 v225, v222, v203
    v_fmac_f32 v220, v219, v226
    v_fmac_f32 v224, v223, v226
    v_fmac_f32 v221, v219, v202
    v_fmac_f32 v225, v223, v202
    v_cvt_pk_bf16_f32 v170, v218, v222
    v_cvt_pk_bf16_f32 v174, v219, v223
    v_mul_f32 v218, v220, v202
    v_mul_f32 v222, v224, v202
    v_mul_f32 v219, v220, v203
    v_mul_f32 v223, v224, v203
    v_fmac_f32 v218, v221, v226
    v_fmac_f32 v222, v225, v226
    v_fmac_f32 v219, v221, v202
    v_fmac_f32 v223, v225, v202
    v_cvt_pk_bf16_f32 v171, v220, v224
    v_cvt_pk_bf16_f32 v175, v221, v225
    v_mul_f32 v220, v218, v202
    v_mfma_f32_32x32x16_bf16 v[128:143], v[168:171], v[56:59], 0
    v_mul_f32 v224, v222, v202
    v_mul_f32 v221, v218, v203
    v_mul_f32 v225, v222, v203
    v_fmac_f32 v220, v219, v226
    v_fmac_f32 v224, v223, v226
    v_mfma_f32_32x32x16_bf16 v[144:159], v[172:175], v[56:59], 0
    v_fmac_f32 v221, v219, v202
    v_fmac_f32 v225, v223, v202
    v_cvt_pk_bf16_f32 v176, v218, v222
    v_cvt_pk_bf16_f32 v180, v219, v223
    v_mul_f32 v218, v220, v202
    v_mul_f32 v222, v224, v202
    v_mul_f32 v219, v220, v203
    v_mul_f32 v223, v224, v203
    v_fmac_f32 v218, v221, v226
    v_fmac_f32 v222, v225, v226
    v_fmac_f32 v219, v221, v202
    v_fmac_f32 v223, v225, v202
    v_cvt_pk_bf16_f32 v177, v220, v224
    v_cvt_pk_bf16_f32 v181, v221, v225
    v_mul_f32 v220, v218, v202
    v_mul_f32 v224, v222, v202
    v_mul_f32 v221, v218, v203
    v_mul_f32 v225, v222, v203
    v_fmac_f32 v220, v219, v226
    v_fmac_f32 v224, v223, v226
    v_fmac_f32 v221, v219, v202
    v_fmac_f32 v225, v223, v202
    v_cvt_pk_bf16_f32 v178, v218, v222
    v_cvt_pk_bf16_f32 v182, v219, v223
    v_mul_f32 v218, v220, v202
    v_mul_f32 v222, v224, v202
    v_mul_f32 v219, v220, v203
    v_mul_f32 v223, v224, v203
    v_fmac_f32 v218, v221, v226
    v_fmac_f32 v222, v225, v226
    v_fmac_f32 v219, v221, v202
    v_fmac_f32 v223, v225, v202
    v_cvt_pk_bf16_f32 v179, v220, v224
    v_cvt_pk_bf16_f32 v183, v221, v225
    v_mul_f32 v220, v218, v202
    v_mfma_f32_32x32x16_bf16 v[128:143], v[176:179], v[60:63], v[128:143]
    v_mul_f32 v224, v222, v202
    v_mul_f32 v221, v218, v203
    v_mul_f32 v225, v222, v203
    v_fmac_f32 v220, v219, v226
    v_fmac_f32 v224, v223, v226
    v_mfma_f32_32x32x16_bf16 v[144:159], v[180:183], v[60:63], v[144:159]
    v_fmac_f32 v221, v219, v202
    v_fmac_f32 v225, v223, v202
    v_cvt_pk_bf16_f32 v160, v218, v222
    v_cvt_pk_bf16_f32 v164, v219, v223
    v_mul_f32 v218, v220, v202
    v_mul_f32 v222, v224, v202
    v_mfma_f32_16x16x32_bf16 v[32:35], v[64:67], v[128:131], v[32:35]
    v_mul_f32 v219, v220, v203
    v_mul_f32 v223, v224, v203
    v_mfma_f32_16x16x32_bf16 v[40:43], v[128:131], v[96:99], v[40:43]
    v_fmac_f32 v218, v221, v226
    v_fmac_f32 v222, v225, v226
    v_mfma_f32_16x16x32_bf16 v[32:35], v[68:71], v[132:135], v[32:35]
    v_fmac_f32 v219, v221, v202
    v_fmac_f32 v223, v225, v202
    v_mfma_f32_16x16x32_bf16 v[40:43], v[132:135], v[100:103], v[40:43]
    v_cvt_pk_bf16_f32 v161, v220, v224
    v_cvt_pk_bf16_f32 v165, v221, v225
    v_mfma_f32_16x16x32_bf16 v[32:35], v[72:75], v[136:139], v[32:35]
    v_mul_f32 v220, v218, v202
    v_mul_f32 v224, v222, v202
    v_mfma_f32_16x16x32_bf16 v[40:43], v[136:139], v[104:107], v[40:43]
    v_mul_f32 v221, v218, v203
    v_mul_f32 v225, v222, v203
    v_mfma_f32_16x16x32_bf16 v[32:35], v[76:79], v[140:143], v[32:35]
    v_fmac_f32 v220, v219, v226
    v_fmac_f32 v224, v223, v226
    v_mfma_f32_16x16x32_bf16 v[40:43], v[140:143], v[108:111], v[40:43]
    v_fmac_f32 v221, v219, v202
    v_fmac_f32 v225, v223, v202
    v_mfma_f32_16x16x32_bf16 v[32:35], v[80:83], v[144:147], v[32:35]
    v_cvt_pk_bf16_f32 v162, v218, v222
    v_cvt_pk_bf16_f32 v166, v219, v223
    v_mfma_f32_16x16x32_bf16 v[40:43], v[144:147], v[112:115], v[40:43]
    v_mul_f32 v218, v220, v202
    v_mul_f32 v222, v224, v202
    v_mfma_f32_16x16x32_bf16 v[32:35], v[84:87], v[148:151], v[32:35]
    v_mul_f32 v219, v220, v203
    v_mul_f32 v223, v224, v203
    v_mfma_f32_16x16x32_bf16 v[40:43], v[148:151], v[116:119], v[40:43]
    v_fmac_f32 v218, v221, v226
    v_fmac_f32 v222, v225, v226
    v_mfma_f32_16x16x32_bf16 v[32:35], v[88:91], v[152:155], v[32:35]
    v_fmac_f32 v219, v221, v202
    v_fmac_f32 v223, v225, v202
    v_mfma_f32_16x16x32_bf16 v[40:43], v[152:155], v[120:123], v[40:43]
    v_cvt_pk_bf16_f32 v163, v220, v224
    v_cvt_pk_bf16_f32 v167, v221, v225
    v_mfma_f32_16x16x32_bf16 v[32:35], v[92:95], v[156:159], v[32:35]
    v_mul_f32 v220, v218, v202
    v_mul_f32 v224, v222, v202
    v_mfma_f32_16x16x32_bf16 v[40:43], v[156:159], v[124:127], v[40:43]
    v_mul_f32 v221, v218, v203
    v_mul_f32 v225, v222, v203
    v_mfma_f32_32x32x16_bf16 v[128:143], v[160:163], v[56:59], 0
    v_fmac_f32 v220, v219, v226
    v_fmac_f32 v224, v223, v226
    v_fmac_f32 v221, v219, v202
    v_fmac_f32 v225, v223, v202
    v_cvt_pk_bf16_f32 v168, v218, v222
    v_mfma_f32_32x32x16_bf16 v[144:159], v[164:167], v[56:59], 0
    v_cvt_pk_bf16_f32 v172, v219, v223
    v_mul_f32 v218, v220, v202
    v_mul_f32 v222, v224, v202
    v_mul_f32 v219, v220, v203
    v_mul_f32 v223, v224, v203
    v_fmac_f32 v218, v221, v226
    v_fmac_f32 v222, v225, v226
    s_waitcnt vmcnt(0)
    v_cmp_ne_u64 vcc, v[10:11], v[8:9]
    s_nop 0
    s_cbranch_vccnz co_sq85
co_ok87:
    buffer_load_dwordx4 v[20:23], v29, s[48:51], s70 offen sc1
    buffer_load_dwordx4 v[24:27], v29, s[48:51], s71 offen sc1
    v_fmac_f32 v219, v221, v202
    v_fmac_f32 v223, v225, v202
    v_cvt_pk_bf16_f32 v169, v220, v224
    v_cvt_pk_bf16_f32 v173, v221, v225
    v_mul_f32 v220, v218, v202
    v_mul_f32 v224, v222, v202
    v_mul_f32 v221, v218, v203
    v_mul_f32 v225, v222, v203
    v_fmac_f32 v220, v219, v226
    v_fmac_f32 v224, v223, v226
    v_fmac_f32 v221, v219, v202
    v_fmac_f32 v225, v223, v202
    v_cvt_pk_bf16_f32 v170, v218, v222
    v_cvt_pk_bf16_f32 v174, v219, v223
    v_cvt_pk_bf16_f32 v171, v220, v224
    v_cvt_pk_bf16_f32 v175, v221, v225
    s_nop 0
    v_mfma_f32_32x32x16_bf16 v[128:143], v[168:171], v[60:63], v[128:143]
    v_mfma_f32_32x32x16_bf16 v[144:159], v[172:175], v[60:63], v[144:159]
    s_nop 10
    v_mfma_f32_16x16x32_bf16 v[36:39], v[64:67], v[128:131], v[36:39]
    v_mfma_f32_16x16x32_bf16 v[44:47], v[128:131], v[96:99], v[44:47]
    v_mfma_f32_16x16x32_bf16 v[36:39], v[68:71], v[132:135], v[36:39]
    v_mfma_f32_16x16x32_bf16 v[44:47], v[132:135], v[100:103], v[44:47]
    v_mfma_f32_16x16x32_bf16 v[36:39], v[72:75], v[136:139], v[36:39]
    v_mfma_f32_16x16x32_bf16 v[44:47], v[136:139], v[104:107], v[44:47]
    v_mfma_f32_16x16x32_bf16 v[36:39], v[76:79], v[140:143], v[36:39]
    v_mfma_f32_16x16x32_bf16 v[44:47], v[140:143], v[108:111], v[44:47]
    v_mfma_f32_16x16x32_bf16 v[36:39], v[80:83], v[144:147], v[36:39]
    v_mfma_f32_16x16x32_bf16 v[44:47], v[144:147], v[112:115], v[44:47]
    v_mfma_f32_16x16x32_bf16 v[36:39], v[84:87], v[148:151], v[36:39]
    v_mfma_f32_16x16x32_bf16 v[44:47], v[148:151], v[116:119], v[44:47]
    v_mfma_f32_16x16x32_bf16 v[36:39], v[88:91], v[152:155], v[36:39]
    v_mfma_f32_16x16x32_bf16 v[44:47], v[152:155], v[120:123], v[44:47]
    v_mfma_f32_16x16x32_bf16 v[36:39], v[92:95], v[156:159], v[36:39]
    v_mfma_f32_16x16x32_bf16 v[44:47], v[156:159], v[124:127], v[44:47]
    ds_write_b64 v31, v[32:33]
    ds_write_b64 v55, v[34:35]
    ds_write_b128 v229, v[40:43] offset:2048
    s_nop 3
    ds_write_b64 v54, v[36:37]
    ds_write_b64 v228, v[38:39]
    ds_write_b128 v229, v[44:47] offset:2112
    ds_add_u32 v236, v6 offset:2304
    ds_read_b32 v7, v236 offset:2304
    v_and_b32 v2, 1, v1
    s_lshl_b32 s14, s8, 12
    s_lshl_b32 s15, s9, 11
    s_add_u32 s14, s14, s15
    s_add_u32 s66, s14, 12582912
    s_lshl_b32 s15, s4, 3
    s_add_u32 s15, s15, s9
    s_lshl_b32 s15, s15, 6
    s_and_b32 s14, s8, 63
    s_add_u32 s15, s15, s14
    s_lshl_b32 s15, s15, 3
    s_add_u32 s67, s15, 14682112
    s_waitcnt lgkmcnt(0)
    v_readfirstlane_b32 s47, v7
    s_nop 0
    s_cmp_lt_u32 s47, 2
    s_cbranch_scc1 co_sp88
co_ok89:
    ds_read2st64_b32 v[50:51], v230 offset0:8 offset1:24
    ds_read2st64_b32 v[58:59], v231 offset0:8 offset1:24
    ds_read2st64_b32 v[48:49], v230 offset0:6 offset1:22
    ds_read2st64_b32 v[56:57], v231 offset0:6 offset1:22
    ds_read2st64_b32 v[16:17], v230 offset0:4 offset1:20
    ds_read2st64_b32 v[52:53], v231 offset0:4 offset1:20
    ds_read_b64 v[12:13], v232
    ds_read_b64 v[14:15], v232 offset:4096
    ds_read_b32 v7, v4 offset:3840
    v_mov_b32 v60, 0
    v_mov_b32 v61, 0
    s_waitcnt lgkmcnt(0)
    v_readfirstlane_b32 s47, v7
    s_nop 0
    s_cmp_lt_u32 s47, 4
    s_cbranch_scc1 co_sp90
co_ok91:
    s_cmp_lg_u32 s9, 0
    s_cbranch_scc1 L_nz
    v_add_u32 v3, s72, v18
    ds_write_b64 v3, v[60:61] offset:8192
    s_mov_b64 exec, 0xff
    ds_write_b64 v3, v[60:61] offset:16896
    ds_write_b64 v3, v[60:61] offset:21040
    s_mov_b64 exec, -1
L_nz:
    v_cmp_eq_u32 vcc, 1, v2
    v_add_f32 v50, v50, v51
    v_add_f32 v58, v58, v59
    v_cndmask_b32 v51, v50, v58, vcc
    v_cvt_pk_bf16_f32 v64, v50, v50
    v_cvt_pk_bf16_f32 v67, v58, v58
    v_cvt_pk_bf16_f32 v66, v51, v58
    v_mov_b32 v65, v64
    ds_write_b128 v233, v[64:67] offset:10752
    v_add_f32 v48, v48, v49
    v_add_f32 v56, v56, v57
    v_cndmask_b32 v49, v48, v56, vcc
    v_cvt_pk_bf16_f32 v62, v48, v48
    v_cvt_pk_bf16_f32 v63, v49, v56
    ds_write_b64 v232, v[62:63] offset:9728
    v_add_f32 v16, v16, v17
    v_add_f32 v52, v52, v53
    v_cndmask_b32 v17, v16, v52, vcc
    v_cvt_pk_bf16_f32 v61, v16, v17
    v_add_f32 v12, v12, v14
    v_add_f32 v13, v13, v15
    v_cvt_pk_bf16_f32 v60, v12, v13
    ds_write2st64_b32 v230, v60, v61 offset0:34 offset1:36
    s_waitcnt vmcnt(1)
    ds_write_b128 v237, v[20:23] offset:12800
    v_alignbit_b32 v68, v21, v20, 16
    v_alignbit_b32 v69, v22, v21, 16
    v_alignbit_b32 v70, v23, v22, 16
    ds_write_b16 v237, v20 offset:16958
    ds_write_b16_d16_hi v237, v23 offset:16972
    ds_write_b96 v237, v[68:70] offset:16960
    s_waitcnt vmcnt(0)
    ds_write_b128 v237, v[24:27] offset:13824
    v_alignbit_b32 v72, v25, v24, 16
    v_alignbit_b32 v73, v26, v25, 16
    v_alignbit_b32 v74, v27, v26, 16
    ds_write_b16 v237, v24 offset:17982
    ds_write_b16_d16_hi v237, v27 offset:17996
    ds_write_b96 v237, v[72:74] offset:17984
    ds_add_u32 v236, v6 offset:2304
    ds_read_b32 v7, v236 offset:2304
    s_waitcnt lgkmcnt(0)
    v_readfirstlane_b32 s47, v7
    s_nop 0
    s_cmp_lt_u32 s47, 4
    s_cbranch_scc1 co_sp92
co_ok93:
    ds_read2_b32 v[12:13], v240 offset0:176 offset1:177
    ds_read2_b32 v[14:15], v240 offset0:178 offset1:179
    ds_read_b128 v[88:91], v234 offset:8672
    ds_read_b128 v[92:95], v234 offset:9184
    ds_read_b128 v[96:99], v234 offset:9696
    ds_read_b128 v[100:103], v234 offset:10208
    ds_read_b128 v[104:107], v234 offset:10720
    ds_read_b128 v[108:111], v234 offset:11232
    ds_read_b128 v[112:115], v234 offset:11744
    ds_read_b128 v[116:119], v234 offset:12256
    ds_read2_b32 v[28:29], v240 offset0:48 offset1:49
    ds_read2_b32 v[30:31], v240 offset0:50 offset1:51
    ds_read2_b32 v[32:33], v241 offset0:176 offset1:177
    ds_read2_b32 v[34:35], v241 offset0:178 offset1:179
    ds_read2_b32 v[36:37], v241 offset0:48 offset1:49
    s_waitcnt lgkmcnt(12)
    v_mfma_f32_16x16x32_bf16 v[152:155], v[12:15], v[88:91], 0
    ds_read2_b32 v[38:39], v241 offset0:50 offset1:51
    s_waitcnt lgkmcnt(12)
    v_mfma_f32_16x16x32_bf16 v[156:159], v[12:15], v[92:95], 0
    ds_read2_b32 v[40:41], v242 offset0:176 offset1:177
    s_waitcnt lgkmcnt(12)
    v_mfma_f32_16x16x32_bf16 v[160:163], v[12:15], v[96:99], 0
    ds_read2_b32 v[42:43], v242 offset0:178 offset1:179
    s_waitcnt lgkmcnt(12)
    v_mfma_f32_16x16x32_bf16 v[164:167], v[12:15], v[100:103], 0
    ds_read2_b32 v[44:45], v242 offset0:48 offset1:49
    s_waitcnt lgkmcnt(12)
    v_mfma_f32_16x16x32_bf16 v[168:171], v[12:15], v[104:107], 0
    ds_read2_b32 v[46:47], v242 offset0:50 offset1:51
    s_waitcnt lgkmcnt(12)
    v_mfma_f32_16x16x32_bf16 v[172:175], v[12:15], v[108:111], 0
    ds_read2_b32 v[48:49], v243 offset0:176 offset1:177
    s_waitcnt lgkmcnt(12)
    v_mfma_f32_16x16x32_bf16 v[176:179], v[12:15], v[112:115], 0
    ds_read2_b32 v[50:51], v243 offset0:178 offset1:179
    s_waitcnt lgkmcnt(12)
    v_mfma_f32_16x16x32_bf16 v[180:183], v[12:15], v[116:119], 0
    ds_read2_b32 v[52:53], v243 offset0:48 offset1:49
    ds_read2_b32 v[54:55], v243 offset0:50 offset1:51
    s_waitcnt lgkmcnt(12)
    v_mfma_f32_16x16x32_bf16 v[156:159], v[28:31], v[88:91], v[156:159]
    ds_read2_b32 v[56:57], v240 offset0:160 offset1:161
    ds_read2_b32 v[58:59], v240 offset0:162 offset1:163
    v_mfma_f32_16x16x32_bf16 v[160:163], v[28:31], v[92:95], v[160:163]
    ds_read_b128 v[120:123], v234 offset:8608
    ds_read_b128 v[124:127], v234 offset:9120
    v_mfma_f32_16x16x32_bf16 v[164:167], v[28:31], v[96:99], v[164:167]
    ds_read_b128 v[128:131], v234 offset:9632
    ds_read_b128 v[132:135], v234 offset:10144
    v_mfma_f32_16x16x32_bf16 v[168:171], v[28:31], v[100:103], v[168:171]
    ds_read_b128 v[136:139], v234 offset:10656
    ds_read_b128 v[140:143], v234 offset:11168
    v_mfma_f32_16x16x32_bf16 v[172:175], v[28:31], v[104:107], v[172:175]
    v_mfma_f32_16x16x32_bf16 v[176:179], v[28:31], v[108:111], v[176:179]
    ds_read_b128 v[144:147], v234 offset:11680
    v_mfma_f32_16x16x32_bf16 v[180:183], v[28:31], v[112:115], v[180:183]
    ds_read_b128 v[148:151], v234 offset:12192
    s_waitcnt lgkmcnt(15)
    v_mfma_f32_16x16x32_bf16 v[160:163], v[32:35], v[88:91], v[160:163]
    v_mfma_f32_16x16x32_bf16 v[164:167], v[32:35], v[92:95], v[164:167]
    ds_read2_b32 v[60:61], v240 offset0:32 offset1:33
    v_mfma_f32_16x16x32_bf16 v[168:171], v[32:35], v[96:99], v[168:171]
    ds_read2_b32 v[62:63], v240 offset0:34 offset1:35
    v_mfma_f32_16x16x32_bf16 v[172:175], v[32:35], v[100:103], v[172:175]
    v_mfma_f32_16x16x32_bf16 v[176:179], v[32:35], v[104:107], v[176:179]
    ds_read2_b32 v[64:65], v241 offset0:160 offset1:161
    v_mfma_f32_16x16x32_bf16 v[180:183], v[32:35], v[108:111], v[180:183]
    ds_read2_b32 v[66:67], v241 offset0:162 offset1:163
    v_mfma_f32_16x16x32_bf16 v[164:167], v[36:39], v[88:91], v[164:167]
    v_mfma_f32_16x16x32_bf16 v[168:171], v[36:39], v[92:95], v[168:171]
    ds_read2_b32 v[68:69], v241 offset0:32 offset1:33
    v_mfma_f32_16x16x32_bf16 v[172:175], v[36:39], v[96:99], v[172:175]
    ds_read2_b32 v[70:71], v241 offset0:34 offset1:35
    v_mfma_f32_16x16x32_bf16 v[176:179], v[36:39], v[100:103], v[176:179]
    v_mfma_f32_16x16x32_bf16 v[180:183], v[36:39], v[104:107], v[180:183]
    ds_read2_b32 v[72:73], v242 offset0:160 offset1:161
    v_mfma_f32_16x16x32_bf16 v[168:171], v[40:43], v[88:91], v[168:171]
    ds_read2_b32 v[74:75], v242 offset0:162 offset1:163
    v_mfma_f32_16x16x32_bf16 v[172:175], v[40:43], v[92:95], v[172:175]
    v_mfma_f32_16x16x32_bf16 v[176:179], v[40:43], v[96:99], v[176:179]
    ds_read2_b32 v[76:77], v242 offset0:32 offset1:33
    v_mfma_f32_16x16x32_bf16 v[180:183], v[40:43], v[100:103], v[180:183]
    ds_read2_b32 v[78:79], v242 offset0:34 offset1:35
    s_waitcnt lgkmcnt(15)
    v_mfma_f32_16x16x32_bf16 v[172:175], v[44:47], v[88:91], v[172:175]
    s_mov_b32 s52, s38
    s_and_b32 s53, s39, 0xffff
    s_mov_b32 s54, 401408
    s_mov_b32 s55, 0x00020000
    v_mfma_f32_16x16x32_bf16 v[176:179], v[44:47], v[92:95], v[176:179]
    ds_read2_b32 v[80:81], v243 offset0:160 offset1:161
    v_mfma_f32_16x16x32_bf16 v[180:183], v[44:47], v[96:99], v[180:183]
    ds_read2_b32 v[82:83], v243 offset0:162 offset1:163
    v_mfma_f32_16x16x32_bf16 v[176:179], v[48:51], v[88:91], v[176:179]
    v_mfma_f32_16x16x32_bf16 v[180:183], v[48:51], v[92:95], v[180:183]
    ds_read2_b32 v[84:85], v243 offset0:32 offset1:33
    v_mfma_f32_16x16x32_bf16 v[180:183], v[52:55], v[88:91], v[180:183]
    ds_read2_b32 v[86:87], v243 offset0:34 offset1:35
    v_mfma_f32_16x16x32_bf16 v[152:155], v[56:59], v[120:123], v[152:155]
    v_mfma_f32_16x16x32_bf16 v[156:159], v[56:59], v[124:127], v[156:159]
    ds_read2_b32 v[12:13], v240 offset0:144 offset1:145
    v_mfma_f32_16x16x32_bf16 v[160:163], v[56:59], v[128:131], v[160:163]
    ds_read2_b32 v[14:15], v240 offset0:146 offset1:147
    s_waitcnt lgkmcnt(15)
    v_mfma_f32_16x16x32_bf16 v[164:167], v[56:59], v[132:135], v[164:167]
    v_mfma_f32_16x16x32_bf16 v[168:171], v[56:59], v[136:139], v[168:171]
    ds_read_b128 v[88:91], v234 offset:8544
    v_mfma_f32_16x16x32_bf16 v[172:175], v[56:59], v[140:143], v[172:175]
    ds_read_b128 v[92:95], v234 offset:9056
    v_mfma_f32_16x16x32_bf16 v[176:179], v[56:59], v[144:147], v[176:179]
    v_mfma_f32_16x16x32_bf16 v[180:183], v[56:59], v[148:151], v[180:183]
    ds_read_b128 v[96:99], v234 offset:9568
    s_waitcnt lgkmcnt(15)
    v_mfma_f32_16x16x32_bf16 v[156:159], v[60:63], v[120:123], v[156:159]
    ds_read_b128 v[100:103], v234 offset:10080
    v_mfma_f32_16x16x32_bf16 v[160:163], v[60:63], v[124:127], v[160:163]
    v_mfma_f32_16x16x32_bf16 v[164:167], v[60:63], v[128:131], v[164:167]
    ds_read_b128 v[104:107], v234 offset:10592
    v_mfma_f32_16x16x32_bf16 v[168:171], v[60:63], v[132:135], v[168:171]
    ds_read_b128 v[108:111], v234 offset:11104
    v_mfma_f32_16x16x32_bf16 v[172:175], v[60:63], v[136:139], v[172:175]
    v_mfma_f32_16x16x32_bf16 v[176:179], v[60:63], v[140:143], v[176:179]
    ds_read_b128 v[112:115], v234 offset:11616
    v_mfma_f32_16x16x32_bf16 v[180:183], v[60:63], v[144:147], v[180:183]
    buffer_store_dwordx4 v[240:243], v5, s[48:51], s29 offen offset:0 sc1
    buffer_store_dwordx4 v[240:243], v5, s[48:51], s29 offen offset:1024 sc1
    s_sub_u32 s14, s29, 6291456
    s_lshr_b32 s14, s14, 2
    s_add_u32 s14, s14, 14745600
    s_mov_b64 exec, 0xffffffff
    buffer_store_dwordx4 v[240:243], v5, s[48:51], s14 offen sc1
    s_mov_b64 exec, -1
    ds_read_b128 v[116:119], v234 offset:12128
    v_mfma_f32_16x16x32_bf16 v[160:163], v[64:67], v[120:123], v[160:163]
    v_mfma_f32_16x16x32_bf16 v[164:167], v[64:67], v[124:127], v[164:167]
    ds_read2_b32 v[28:29], v240 offset0:16 offset1:17
    v_mfma_f32_16x16x32_bf16 v[168:171], v[64:67], v[128:131], v[168:171]
    ds_read2_b32 v[30:31], v240 offset0:18 offset1:19
    v_mfma_f32_16x16x32_bf16 v[172:175], v[64:67], v[132:135], v[172:175]
    v_mfma_f32_16x16x32_bf16 v[176:179], v[64:67], v[136:139], v[176:179]
    ds_read2_b32 v[32:33], v241 offset0:144 offset1:145
    v_mfma_f32_16x16x32_bf16 v[180:183], v[64:67], v[140:143], v[180:183]
    ds_read_b32 v7, v4 offset:2048
    ds_read2_b32 v[34:35], v241 offset0:146 offset1:147
    s_waitcnt lgkmcnt(15)
    v_mfma_f32_16x16x32_bf16 v[164:167], v[68:71], v[120:123], v[164:167]
    v_mfma_f32_16x16x32_bf16 v[168:171], v[68:71], v[124:127], v[168:171]
    ds_read2_b32 v[36:37], v241 offset0:16 offset1:17
    v_mfma_f32_16x16x32_bf16 v[172:175], v[68:71], v[128:131], v[172:175]
    ds_read2_b32 v[38:39], v241 offset0:18 offset1:19
    v_mfma_f32_16x16x32_bf16 v[176:179], v[68:71], v[132:135], v[176:179]
    s_waitcnt lgkmcnt(3)
    v_readfirstlane_b32 s47, v7
    s_nop 0
    s_cmp_lt_u32 s47, 8
    s_cbranch_scc1 co_sp94
co_ok95:
    s_add_u32 m0, s25, 0
    s_add_u32 s14, s24, 0
    buffer_load_dwordx4 v247, s[52:55], s14 offen lds
    v_mfma_f32_16x16x32_bf16 v[180:183], v[68:71], v[136:139], v[180:183]
    ds_read2_b32 v[40:41], v242 offset0:144 offset1:145
    v_mfma_f32_16x16x32_bf16 v[168:171], v[72:75], v[120:123], v[168:171]
    s_add_u32 m0, s25, 1024
    s_add_u32 s14, s24, 3584
    buffer_load_dwordx4 v247, s[52:55], s14 offen lds
    ds_read2_b32 v[42:43], v242 offset0:146 offset1:147
    v_mfma_f32_16x16x32_bf16 v[172:175], v[72:75], v[124:127], v[172:175]
    v_mfma_f32_16x16x32_bf16 v[176:179], v[72:75], v[128:131], v[176:179]
    s_add_u32 m0, s25, 2048
    s_add_u32 s14, s24, 7168
    buffer_load_dwordx4 v247, s[52:55], s14 offen lds
    ds_read2_b32 v[44:45], v242 offset0:16 offset1:17
    v_mfma_f32_16x16x32_bf16 v[180:183], v[72:75], v[132:135], v[180:183]
    ds_read2_b32 v[46:47], v242 offset0:18 offset1:19
    v_mfma_f32_16x16x32_bf16 v[172:175], v[76:79], v[120:123], v[172:175]
    s_add_u32 m0, s25, 3072
    s_add_u32 s14, s24, 10752
    buffer_load_dwordx4 v247, s[52:55], s14 offen lds
    v_mfma_f32_16x16x32_bf16 v[176:179], v[76:79], v[124:127], v[176:179]
    ds_read2_b32 v[48:49], v243 offset0:144 offset1:145
    v_mfma_f32_16x16x32_bf16 v[180:183], v[76:79], v[128:131], v[180:183]
    s_add_u32 m0, s25, 4096
    s_add_u32 s14, s24, 14336
    buffer_load_dwordx4 v247, s[52:55], s14 offen lds
    ds_read2_b32 v[50:51], v243 offset0:146 offset1:147
    v_mfma_f32_16x16x32_bf16 v[176:179], v[80:83], v[120:123], v[176:179]
    v_mfma_f32_16x16x32_bf16 v[180:183], v[80:83], v[124:127], v[180:183]
    s_add_u32 m0, s25, 5120
    s_add_u32 s14, s24, 17920
    buffer_load_dwordx4 v247, s[52:55], s14 offen lds
    ds_read2_b32 v[52:53], v243 offset0:16 offset1:17
    v_mfma_f32_16x16x32_bf16 v[180:183], v[84:87], v[120:123], v[180:183]
    ds_read2_b32 v[54:55], v243 offset0:18 offset1:19
    v_mfma_f32_16x16x32_bf16 v[152:155], v[12:15], v[88:91], v[152:155]
    s_add_u32 m0, s25, 6144
    s_add_u32 s14, s24, 21504
    buffer_load_dwordx4 v247, s[52:55], s14 offen lds
    v_mfma_f32_16x16x32_bf16 v[156:159], v[12:15], v[92:95], v[156:159]
    ds_read2_b32 v[56:57], v240 offset0:128 offset1:129
    v_mfma_f32_16x16x32_bf16 v[160:163], v[12:15], v[96:99], v[160:163]
    s_add_u32 m0, s25, 7168
    s_add_u32 s14, s24, 25088
    buffer_load_dwordx4 v247, s[52:55], s14 offen lds
    ds_read2_b32 v[58:59], v240 offset0:130 offset1:131
    v_mfma_f32_16x16x32_bf16 v[164:167], v[12:15], v[100:103], v[164:167]
    v_mfma_f32_16x16x32_bf16 v[168:171], v[12:15], v[104:107], v[168:171]
    s_add_u32 m0, s25, 8192
    s_add_u32 s14, s24, 28672
    buffer_load_dwordx4 v247, s[52:55], s14 offen lds
    ds_read_b128 v[120:123], v234 offset:8480
    v_mfma_f32_16x16x32_bf16 v[172:175], v[12:15], v[108:111], v[172:175]
    ds_read_b128 v[124:127], v234 offset:8992
    v_mfma_f32_16x16x32_bf16 v[176:179], v[12:15], v[112:115], v[176:179]
    s_add_u32 m0, s25, 9216
    s_add_u32 s14, s24, 32256
    buffer_load_dwordx4 v247, s[52:55], s14 offen lds
    v_mfma_f32_16x16x32_bf16 v[180:183], v[12:15], v[116:119], v[180:183]
    ds_read_b128 v[128:131], v234 offset:9504
    v_mfma_f32_16x16x32_bf16 v[156:159], v[28:31], v[88:91], v[156:159]
    s_add_u32 m0, s25, 10240
    s_add_u32 s14, s24, 35840
    buffer_load_dwordx4 v247, s[52:55], s14 offen lds
    ds_read_b128 v[132:135], v234 offset:10016
    v_mfma_f32_16x16x32_bf16 v[160:163], v[28:31], v[92:95], v[160:163]
    v_mfma_f32_16x16x32_bf16 v[164:167], v[28:31], v[96:99], v[164:167]
    s_add_u32 m0, s25, 11264
    s_add_u32 s14, s24, 39424
    buffer_load_dwordx4 v247, s[52:55], s14 offen lds
    ds_read_b128 v[136:139], v234 offset:10528
    v_mfma_f32_16x16x32_bf16 v[168:171], v[28:31], v[100:103], v[168:171]
    ds_read_b128 v[140:143], v234 offset:11040
    v_mfma_f32_16x16x32_bf16 v[172:175], v[28:31], v[104:107], v[172:175]
    s_add_u32 m0, s25, 12288
    s_add_u32 s14, s24, 43008
    buffer_load_dwordx4 v247, s[52:55], s14 offen lds
    v_mfma_f32_16x16x32_bf16 v[176:179], v[28:31], v[108:111], v[176:179]
    ds_read_b128 v[144:147], v234 offset:11552
    v_mfma_f32_16x16x32_bf16 v[180:183], v[28:31], v[112:115], v[180:183]
    s_add_u32 m0, s25, 13312
    s_add_u32 s14, s24, 46592
    buffer_load_dwordx4 v247, s[52:55], s14 offen lds
    ds_read_b128 v[148:151], v234 offset:12064
    s_waitcnt lgkmcnt(15)
    v_mfma_f32_16x16x32_bf16 v[160:163], v[32:35], v[88:91], v[160:163]
    v_mfma_f32_16x16x32_bf16 v[164:167], v[32:35], v[92:95], v[164:167]
    s_add_u32 m0, s25, 14336
    s_add_u32 s14, s24, 50176
    buffer_load_dwordx4 v247, s[52:55], s14 offen lds
    ds_read2_b32 v[60:61], v240 offset0:0 offset1:1
    v_mfma_f32_16x16x32_bf16 v[168:171], v[32:35], v[96:99], v[168:171]
    ds_read2_b32 v[62:63], v240 offset0:2 offset1:3
    v_mfma_f32_16x16x32_bf16 v[172:175], v[32:35], v[100:103], v[172:175]
    s_add_u32 m0, s25, 15360
    s_add_u32 s14, s24, 53760
    buffer_load_dwordx4 v247, s[52:55], s14 offen lds
    v_mfma_f32_16x16x32_bf16 v[176:179], v[32:35], v[104:107], v[176:179]
    ds_read2_b32 v[64:65], v241 offset0:128 offset1:129
    v_mfma_f32_16x16x32_bf16 v[180:183], v[32:35], v[108:111], v[180:183]
    s_add_u32 m0, s25, 16384
    s_add_u32 s14, s24, 57344
    buffer_load_dwordx4 v247, s[52:55], s14 offen lds
    ds_read2_b32 v[66:67], v241 offset0:130 offset1:131
    v_mfma_f32_16x16x32_bf16 v[164:167], v[36:39], v[88:91], v[164:167]
    v_mfma_f32_16x16x32_bf16 v[168:171], v[36:39], v[92:95], v[168:171]
    s_add_u32 m0, s25, 17408
    s_add_u32 s14, s24, 60928
    buffer_load_dwordx4 v247, s[52:55], s14 offen lds
    ds_read2_b32 v[68:69], v241 offset0:0 offset1:1
    v_mfma_f32_16x16x32_bf16 v[172:175], v[36:39], v[96:99], v[172:175]
    ds_read2_b32 v[70:71], v241 offset0:2 offset1:3
    v_mfma_f32_16x16x32_bf16 v[176:179], v[36:39], v[100:103], v[176:179]
    s_add_u32 m0, s25, 18432
    s_add_u32 s14, s24, 64512
    buffer_load_dwordx4 v247, s[52:55], s14 offen lds
    v_mfma_f32_16x16x32_bf16 v[180:183], v[36:39], v[104:107], v[180:183]
    ds_read2_b32 v[72:73], v242 offset0:128 offset1:129
    v_mfma_f32_16x16x32_bf16 v[168:171], v[40:43], v[88:91], v[168:171]
    s_add_u32 m0, s25, 19456
    s_add_u32 s14, s24, 68096
    buffer_load_dwordx4 v247, s[52:55], s14 offen lds
    ds_read2_b32 v[74:75], v242 offset0:130 offset1:131
    v_mfma_f32_16x16x32_bf16 v[172:175], v[40:43], v[92:95], v[172:175]
    v_mfma_f32_16x16x32_bf16 v[176:179], v[40:43], v[96:99], v[176:179]
    s_add_u32 m0, s25, 20480
    s_add_u32 s14, s24, 71680
    buffer_load_dwordx4 v247, s[52:55], s14 offen lds
    ds_read2_b32 v[76:77], v242 offset0:0 offset1:1
    v_mfma_f32_16x16x32_bf16 v[180:183], v[40:43], v[100:103], v[180:183]
    ds_read2_b32 v[78:79], v242 offset0:2 offset1:3
    s_waitcnt lgkmcnt(15)
    v_mfma_f32_16x16x32_bf16 v[172:175], v[44:47], v[88:91], v[172:175]
    s_add_u32 m0, s25, 21504
    s_add_u32 s14, s24, 75264
    buffer_load_dwordx4 v247, s[52:55], s14 offen lds
    v_mfma_f32_16x16x32_bf16 v[176:179], v[44:47], v[92:95], v[176:179]
    ds_read2_b32 v[80:81], v243 offset0:128 offset1:129
    v_mfma_f32_16x16x32_bf16 v[180:183], v[44:47], v[96:99], v[180:183]
    s_add_u32 m0, s25, 22528
    s_add_u32 s14, s24, 78848
    buffer_load_dwordx4 v247, s[52:55], s14 offen lds
    ds_read2_b32 v[82:83], v243 offset0:130 offset1:131
    v_mfma_f32_16x16x32_bf16 v[176:179], v[48:51], v[88:91], v[176:179]
    v_mfma_f32_16x16x32_bf16 v[180:183], v[48:51], v[92:95], v[180:183]
    s_add_u32 m0, s25, 23552
    s_add_u32 s14, s24, 82432
    buffer_load_dwordx4 v247, s[52:55], s14 offen lds
    ds_read2_b32 v[84:85], v243 offset0:0 offset1:1
    v_mfma_f32_16x16x32_bf16 v[180:183], v[52:55], v[88:91], v[180:183]
    ds_read2_b32 v[86:87], v243 offset0:2 offset1:3
    v_mfma_f32_16x16x32_bf16 v[152:155], v[56:59], v[120:123], v[152:155]
    s_add_u32 m0, s25, 24576
    s_add_u32 s14, s24, 86016
    buffer_load_dwordx4 v247, s[52:55], s14 offen lds
    v_mfma_f32_16x16x32_bf16 v[156:159], v[56:59], v[124:127], v[156:159]
    v_mfma_f32_16x16x32_bf16 v[160:163], v[56:59], v[128:131], v[160:163]
    s_add_u32 m0, s25, 25600
    s_add_u32 s14, s24, 89600
    buffer_load_dwordx4 v247, s[52:55], s14 offen lds
    s_waitcnt lgkmcnt(15)
    v_mfma_f32_16x16x32_bf16 v[164:167], v[56:59], v[132:135], v[164:167]
    v_mfma_f32_16x16x32_bf16 v[168:171], v[56:59], v[136:139], v[168:171]
    s_add_u32 m0, s25, 26624
    s_add_u32 s14, s24, 93184
    buffer_load_dwordx4 v247, s[52:55], s14 offen lds
    v_mfma_f32_16x16x32_bf16 v[172:175], v[56:59], v[140:143], v[172:175]
    v_mfma_f32_16x16x32_bf16 v[176:179], v[56:59], v[144:147], v[176:179]
    s_add_u32 m0, s25, 27648
    s_add_u32 s14, s24, 96768
    buffer_load_dwordx4 v247, s[52:55], s14 offen lds
    s_waitcnt lgkmcnt(14)
    v_mfma_f32_16x16x32_bf16 v[180:183], v[56:59], v[148:151], v[180:183]
    s_waitcnt lgkmcnt(12)
    v_mfma_f32_16x16x32_bf16 v[156:159], v[60:63], v[120:123], v[156:159]
    v_mfma_f32_16x16x32_bf16 v[160:163], v[60:63], v[124:127], v[160:163]
    v_mfma_f32_16x16x32_bf16 v[164:167], v[60:63], v[128:131], v[164:167]
    v_mfma_f32_16x16x32_bf16 v[168:171], v[60:63], v[132:135], v[168:171]
    v_mfma_f32_16x16x32_bf16 v[172:175], v[60:63], v[136:139], v[172:175]
    v_mfma_f32_16x16x32_bf16 v[176:179], v[60:63], v[140:143], v[176:179]
    v_mfma_f32_16x16x32_bf16 v[180:183], v[60:63], v[144:147], v[180:183]
    s_waitcnt lgkmcnt(10)
    v_mfma_f32_16x16x32_bf16 v[160:163], v[64:67], v[120:123], v[160:163]
    v_mfma_f32_16x16x32_bf16 v[164:167], v[64:67], v[124:127], v[164:167]
    v_mfma_f32_16x16x32_bf16 v[168:171], v[64:67], v[128:131], v[168:171]
    v_mfma_f32_16x16x32_bf16 v[172:175], v[64:67], v[132:135], v[172:175]
    v_mfma_f32_16x16x32_bf16 v[176:179], v[64:67], v[136:139], v[176:179]
    v_mfma_f32_16x16x32_bf16 v[180:183], v[64:67], v[140:143], v[180:183]
    s_waitcnt lgkmcnt(8)
    v_mfma_f32_16x16x32_bf16 v[164:167], v[68:71], v[120:123], v[164:167]
    v_mfma_f32_16x16x32_bf16 v[168:171], v[68:71], v[124:127], v[168:171]
    v_mfma_f32_16x16x32_bf16 v[172:175], v[68:71], v[128:131], v[172:175]
    v_mfma_f32_16x16x32_bf16 v[176:179], v[68:71], v[132:135], v[176:179]
    v_mfma_f32_16x16x32_bf16 v[180:183], v[68:71], v[136:139], v[180:183]
    s_waitcnt lgkmcnt(6)
    v_mfma_f32_16x16x32_bf16 v[168:171], v[72:75], v[120:123], v[168:171]
    v_mfma_f32_16x16x32_bf16 v[172:175], v[72:75], v[124:127], v[172:175]
    v_mfma_f32_16x16x32_bf16 v[176:179], v[72:75], v[128:131], v[176:179]
    v_mfma_f32_16x16x32_bf16 v[180:183], v[72:75], v[132:135], v[180:183]
    s_waitcnt lgkmcnt(4)
    v_mfma_f32_16x16x32_bf16 v[172:175], v[76:79], v[120:123], v[172:175]
    v_mfma_f32_16x16x32_bf16 v[176:179], v[76:79], v[124:127], v[176:179]
    v_mfma_f32_16x16x32_bf16 v[180:183], v[76:79], v[128:131], v[180:183]
    s_waitcnt lgkmcnt(2)
    v_mfma_f32_16x16x32_bf16 v[176:179], v[80:83], v[120:123], v[176:179]
    v_mfma_f32_16x16x32_bf16 v[180:183], v[80:83], v[124:127], v[180:183]
    s_waitcnt lgkmcnt(0)
    v_mfma_f32_16x16x32_bf16 v[180:183], v[84:87], v[120:123], v[180:183]
    s_setprio 3
    s_cmp_lg_u32 s9, 0
    s_cbranch_scc1 L_c1
    ds_write_b128 v238, v[168:171] offset:0
    ds_write_b128 v238, v[172:175] offset:1024
    ds_write_b128 v238, v[176:179] offset:2048
    s_nop 1
    ds_write_b128 v238, v[180:183] offset:3072
    ds_add_u32 v236, v6 offset:2304
    ds_read_b32 v7, v236 offset:2304
    s_waitcnt lgkmcnt(0)
    v_readfirstlane_b32 s47, v7
    s_nop 0
    s_cmp_lt_u32 s47, 6
    s_cbranch_scc1 co_sp96
co_ok97:
    ds_read_b128 v[12:15], v239 offset:0
    ds_read_b128 v[28:31], v239 offset:1024
    ds_read_b128 v[32:35], v239 offset:2048
    ds_read_b128 v[36:39], v239 offset:3072
    ds_add_u32 v4, v6 offset:3584
    s_waitcnt lgkmcnt(4)
    v_add_f32 v152, v152, v12
    v_add_f32 v153, v153, v13
    v_add_f32 v154, v154, v14
    v_add_f32 v155, v155, v15
    v_cvt_pk_bf16_f32 v184, v152, v153
    v_cvt_pk_bf16_f32 v185, v154, v155
    buffer_store_dwordx2 v[184:185], v235, s[48:51], s66 offen offset:0 sc1
    s_waitcnt lgkmcnt(3)
    v_add_f32 v156, v156, v28
    v_add_f32 v157, v157, v29
    v_add_f32 v158, v158, v30
    v_add_f32 v159, v159, v31
    v_cvt_pk_bf16_f32 v186, v156, v157
    v_cvt_pk_bf16_f32 v187, v158, v159
    buffer_store_dwordx2 v[186:187], v235, s[48:51], s66 offen offset:512 sc1
    s_waitcnt lgkmcnt(2)
    v_add_f32 v160, v160, v32
    v_add_f32 v161, v161, v33
    v_add_f32 v162, v162, v34
    v_add_f32 v163, v163, v35
    v_cvt_pk_bf16_f32 v188, v160, v161
    v_cvt_pk_bf16_f32 v189, v162, v163
    buffer_store_dwordx2 v[188:189], v235, s[48:51], s66 offen offset:1024 sc1
    s_waitcnt lgkmcnt(1)
    v_add_f32 v164, v164, v36
    v_add_f32 v165, v165, v37
    v_add_f32 v166, v166, v38
    v_add_f32 v167, v167, v39
    v_cvt_pk_bf16_f32 v190, v164, v165
    v_cvt_pk_bf16_f32 v191, v166, v167
    buffer_store_dwordx2 v[190:191], v235, s[48:51], s66 offen offset:1536 sc1
    s_branch L_c2
L_c1:
    ds_write_b128 v238, v[152:155] offset:0
    ds_write_b128 v238, v[156:159] offset:1024
    ds_write_b128 v238, v[160:163] offset:2048
    ds_write_b128 v238, v[164:167] offset:3072
    ds_add_u32 v236, v6 offset:2304
    ds_read_b32 v7, v236 offset:2304
    s_waitcnt lgkmcnt(0)
    v_readfirstlane_b32 s47, v7
    s_nop 0
    s_cmp_lt_u32 s47, 6
    s_cbranch_scc1 co_sp98
co_ok99:
    ds_read_b128 v[12:15], v239 offset:0
    ds_read_b128 v[28:31], v239 offset:1024
    ds_read_b128 v[32:35], v239 offset:2048
    ds_read_b128 v[36:39], v239 offset:3072
    ds_add_u32 v4, v6 offset:3584
    s_waitcnt lgkmcnt(4)
    v_add_f32 v168, v168, v12
    v_add_f32 v169, v169, v13
    v_add_f32 v170, v170, v14
    v_add_f32 v171, v171, v15
    v_cvt_pk_bf16_f32 v184, v168, v169
    v_cvt_pk_bf16_f32 v185, v170, v171
    buffer_store_dwordx2 v[184:185], v235, s[48:51], s66 offen offset:0 sc1
    s_waitcnt lgkmcnt(3)
    v_add_f32 v172, v172, v28
    v_add_f32 v173, v173, v29
    v_add_f32 v174, v174, v30
    v_add_f32 v175, v175, v31
    v_cvt_pk_bf16_f32 v186, v172, v173
    v_cvt_pk_bf16_f32 v187, v174, v175
    buffer_store_dwordx2 v[186:187], v235, s[48:51], s66 offen offset:512 sc1
    s_waitcnt lgkmcnt(2)
    v_add_f32 v176, v176, v32
    v_add_f32 v177, v177, v33
    v_add_f32 v178, v178, v34
    v_add_f32 v179, v179, v35
    v_cvt_pk_bf16_f32 v188, v176, v177
    v_cvt_pk_bf16_f32 v189, v178, v179
    buffer_store_dwordx2 v[188:189], v235, s[48:51], s66 offen offset:1024 sc1
    s_waitcnt lgkmcnt(1)
    v_add_f32 v180, v180, v36
    v_add_f32 v181, v181, v37
    v_add_f32 v182, v182, v38
    v_add_f32 v183, v183, v39
    v_cvt_pk_bf16_f32 v190, v180, v181
    v_cvt_pk_bf16_f32 v191, v182, v183
    buffer_store_dwordx2 v[190:191], v235, s[48:51], s66 offen offset:1536 sc1
L_c2:
    s_setprio 0
    s_waitcnt vmcnt(0)
    ds_add_u32 v4, v6 offset:2816
    s_mov_b64 exec, 1
    buffer_store_dwordx2 v[8:9], off, s[48:51], s67
    s_bitset1_b32 s67, 15
    buffer_store_dwordx2 v[8:9], off, s[48:51], s67 sc1
    s_mov_b64 exec, -1
    s_branch L_A3
L_A2:
    s_waitcnt lgkmcnt(0)
    s_barrier
    s_mov_b32 s48, s44
    s_and_b32 s49, s45, 0xffff
    s_mov_b32 s50, 268435456
    s_mov_b32 s51, 0x00020000
    s_mov_b32 s60, s42
    s_and_b32 s61, s43, 0xffff
    s_mov_b32 s62, 256
    s_mov_b32 s63, 0x00020000
    s_cmp_lg_u32 s3, 0
    s_cbranch_scc1 co_pf100
    s_lshr_b32 s14, s75, 1
    s_lshr_b32 s15, s2, 3
    s_cmp_lt_u32 s15, 8
    s_cselect_b32 s14, s14, s4
    s_cselect_b32 s15, s15, s5
    s_lshl_b32 s14, s14, 5
    s_add_u32 s14, s14, s15
    s_lshl_b32 s14, s14, 7
    s_add_u32 s14, s14, 14680064
    s_mov_b64 exec, 1
    buffer_load_dword v10, off, s[48:51], s14 sc1
    s_mov_b64 exec, -1
co_pf100:
    s_mov_b32 s52, s38
    s_and_b32 s53, s39, 0xffff
    s_mov_b32 s54, 401408
    s_mov_b32 s55, 0x00020000
    v_lshrrev_b32 v2, 4, v1
    v_lshlrev_b32 v3, 2, v2
    v_mul_u32_u24 v2, 896, v2
    v_xor_b32 v3, v3, v1
    v_and_b32 v3, 15, v3
    v_min_u32 v3, 13, v3
    v_lshl_add_u32 v247, v3, 4, v2
    s_and_b32 s14, s5, 3
    s_mul_i32 s14, s14, 224
    s_mul_i32 s24, s3, 100352
    s_add_u32 s24, s24, s14
    s_mul_i32 s25, s3, 28672
    s_lshl_b32 s29, s6, 2
    s_add_u32 s29, s29, s3
    s_lshl_b32 s29, s29, 4
    s_add_u32 s29, s29, s75
    s_lshl_b32 s29, s29, 11
    s_add_u32 s29, s29, 6291456
    s_mul_i32 s14, s3, 56
    v_bfe_u32 v2, v1, 4, 1
    v_lshl_add_u32 v251, v2, 5, s14
    v_and_b32 v2, 3, v1
    v_lshl_add_u32 v251, v2, 3, v251
    v_bfe_u32 v2, v1, 2, 2
    v_lshrrev_b32 v3, 5, v1
    v_lshl_add_u32 v248, v3, 2, v2
    v_mad_u32_u24 v249, v3, 3, v2
    v_add_u32 v250, 6, v249
    v_and_b32 v2, 3, v248
    v_lshlrev_b32 v2, 6, v2
    v_xor_b32 v2, v2, v251
    v_lshl_add_u32 v248, v248, 8, v2
    v_and_b32 v2, 3, v249
    v_lshlrev_b32 v2, 6, v2
    v_xor_b32 v2, v2, v251
    v_lshl_add_u32 v249, v249, 8, v2
    v_and_b32 v2, 3, v250
    v_lshlrev_b32 v2, 6, v2
    v_xor_b32 v2, v2, v251
    v_lshl_add_u32 v250, v250, 8, v2
    v_add_u32 v251, 57344, v248
    v_add_u32 v252, 57344, v249
    v_add_u32 v253, 57344, v250
    s_mov_b32 s56, s40
    s_and_b32 s57, s41, 0xffff
    s_mov_b32 s58, 3670016
    s_mov_b32 s59, 0x00020000
    v_mov_b32 v18, 0
    v_mov_b32 v244, 0
    v_mov_b32 v245, 0
    v_mov_b32 v246, 0
    v_mov_b32 v24, 0
    v_mov_b32 v25, 0
    v_mov_b32 v26, 0
    v_mov_b32 v27, 0
    buffer_store_dwordx4 v[24:27], v5, s[48:51], s29 offen offset:0 sc1
    buffer_store_dwordx4 v[24:27], v5, s[48:51], s29 offen offset:1024 sc1
    s_sub_u32 s14, s29, 6291456
    s_lshr_b32 s14, s14, 2
    s_add_u32 s14, s14, 14745600
    s_mov_b64 exec, 0xffffffff
    buffer_store_dwordx4 v[24:27], v5, s[48:51], s14 offen sc1
    s_mov_b64 exec, -1
    s_mov_b64 s[18:19], 0
    s_mov_b64 s[20:21], 0
    s_mov_b64 s[22:23], 0
    ds_add_u32 v4, v6 offset:3584
    s_waitcnt vmcnt(0)
    ds_read_b32 v7, v4 offset:2048
    s_waitcnt lgkmcnt(0)
    v_readfirstlane_b32 s47, v7
    s_nop 0
    s_cmp_lt_u32 s47, 8
    s_cbranch_scc1 co_sp101
co_ok102:
    buffer_load_dwordx2 v[8:9], off, s[60:63], 0 sc1
    s_add_u32 m0, s25, 0
    s_add_u32 s14, s24, 0
    buffer_load_dwordx4 v247, s[52:55], s14 offen lds
    s_add_u32 m0, s25, 1024
    s_add_u32 s14, s24, 3584
    buffer_load_dwordx4 v247, s[52:55], s14 offen lds
    s_add_u32 m0, s25, 2048
    s_add_u32 s14, s24, 7168
    buffer_load_dwordx4 v247, s[52:55], s14 offen lds
    s_add_u32 m0, s25, 3072
    s_add_u32 s14, s24, 10752
    buffer_load_dwordx4 v247, s[52:55], s14 offen lds
    s_add_u32 m0, s25, 4096
    s_add_u32 s14, s24, 14336
    buffer_load_dwordx4 v247, s[52:55], s14 offen lds
    s_waitcnt vmcnt(4)
    s_add_u32 m0, s25, 5120
    s_add_u32 s14, s24, 17920
    buffer_load_dwordx4 v247, s[52:55], s14 offen lds
    s_waitcnt vmcnt(4)
    s_add_u32 m0, s25, 6144
    s_add_u32 s14, s24, 21504
    buffer_load_dwordx4 v247, s[52:55], s14 offen lds
    s_waitcnt vmcnt(4)
    s_add_u32 m0, s25, 7168
    s_add_u32 s14, s24, 25088
    buffer_load_dwordx4 v247, s[52:55], s14 offen lds
    s_waitcnt vmcnt(4)
    s_add_u32 m0, s25, 8192
    s_add_u32 s14, s24, 28672
    buffer_load_dwordx4 v247, s[52:55], s14 offen lds
    s_waitcnt vmcnt(4)
    s_add_u32 m0, s25, 9216
    s_add_u32 s14, s24, 32256
    buffer_load_dwordx4 v247, s[52:55], s14 offen lds
    s_waitcnt vmcnt(4)
    s_add_u32 m0, s25, 10240
    s_add_u32 s14, s24, 35840
    buffer_load_dwordx4 v247, s[52:55], s14 offen lds
    s_waitcnt vmcnt(4)
    s_add_u32 m0, s25, 11264
    s_add_u32 s14, s24, 39424
    buffer_load_dwordx4 v247, s[52:55], s14 offen lds
    s_waitcnt vmcnt(4)
    s_add_u32 m0, s25, 12288
    s_add_u32 s14, s24, 43008
    buffer_load_dwordx4 v247, s[52:55], s14 offen lds
    s_waitcnt vmcnt(4)
    s_add_u32 m0, s25, 13312
    s_add_u32 s14, s24, 46592
    buffer_load_dwordx4 v247, s[52:55], s14 offen lds
    s_waitcnt vmcnt(4)
    s_add_u32 m0, s25, 14336
    s_add_u32 s14, s24, 50176
    buffer_load_dwordx4 v247, s[52:55], s14 offen lds
    s_waitcnt vmcnt(4)
    s_add_u32 m0, s25, 15360
    s_add_u32 s14, s24, 53760
    buffer_load_dwordx4 v247, s[52:55], s14 offen lds
    s_waitcnt vmcnt(4)
    s_add_u32 m0, s25, 16384
    s_add_u32 s14, s24, 57344
    buffer_load_dwordx4 v247, s[52:55], s14 offen lds
    s_waitcnt vmcnt(4)
    s_add_u32 m0, s25, 17408
    s_add_u32 s14, s24, 60928
    buffer_load_dwordx4 v247, s[52:55], s14 offen lds
    s_waitcnt vmcnt(4)
    s_add_u32 m0, s25, 18432
    s_add_u32 s14, s24, 64512
    buffer_load_dwordx4 v247, s[52:55], s14 offen lds
    s_waitcnt vmcnt(4)
    s_add_u32 m0, s25, 19456
    s_add_u32 s14, s24, 68096
    buffer_load_dwordx4 v247, s[52:55], s14 offen lds
    s_waitcnt vmcnt(4)
    s_add_u32 m0, s25, 20480
    s_add_u32 s14, s24, 71680
    buffer_load_dwordx4 v247, s[52:55], s14 offen lds
    s_waitcnt vmcnt(4)
    s_add_u32 m0, s25, 21504
    s_add_u32 s14, s24, 75264
    buffer_load_dwordx4 v247, s[52:55], s14 offen lds
    s_waitcnt vmcnt(4)
    s_add_u32 m0, s25, 22528
    s_add_u32 s14, s24, 78848
    buffer_load_dwordx4 v247, s[52:55], s14 offen lds
    s_waitcnt vmcnt(4)
    s_add_u32 m0, s25, 23552
    s_add_u32 s14, s24, 82432
    buffer_load_dwordx4 v247, s[52:55], s14 offen lds
    s_waitcnt vmcnt(4)
    s_add_u32 m0, s25, 24576
    s_add_u32 s14, s24, 86016
    buffer_load_dwordx4 v247, s[52:55], s14 offen lds
    s_waitcnt vmcnt(4)
    s_add_u32 m0, s25, 25600
    s_add_u32 s14, s24, 89600
    buffer_load_dwordx4 v247, s[52:55], s14 offen lds
    s_waitcnt vmcnt(4)
    s_add_u32 m0, s25, 26624
    s_add_u32 s14, s24, 93184
    buffer_load_dwordx4 v247, s[52:55], s14 offen lds
    s_waitcnt vmcnt(4)
    s_add_u32 m0, s25, 27648
    s_add_u32 s14, s24, 96768
    buffer_load_dwordx4 v247, s[52:55], s14 offen lds
    s_waitcnt vmcnt(4)
    s_waitcnt vmcnt(0)
    v_cmp_eq_u32 vcc, 0, v8
    s_nop 0
    s_cbranch_vccnz co_sp103
co_ok104:
    ds_add_u32 v4, v6 offset:2816
    s_setprio 3
    s_setprio 0
L_A3:
    ds_read_b32 v7, v4 offset:2816
    s_waitcnt lgkmcnt(0)
    v_readfirstlane_b32 s47, v7
    s_nop 0
    s_cmp_lt_u32 s47, 4
    s_cbranch_scc1 co_sp105
co_ok106:
    ds_read_b64_tr_b16 v[32:33], v248 offset:0
    ds_read_b64_tr_b16 v[34:35], v249 offset:4096
    ds_read_b64_tr_b16 v[36:37], v248 offset:2048
    ds_read_b64_tr_b16 v[38:39], v250 offset:4096
    ds_read_b64_tr_b16 v[40:41], v248 offset:7168
    ds_read_b64_tr_b16 v[42:43], v249 offset:11264
    ds_read_b64_tr_b16 v[44:45], v248 offset:9216
    ds_read_b64_tr_b16 v[46:47], v250 offset:11264
    ds_read_b64_tr_b16 v[48:49], v248 offset:14336
    ds_read_b64_tr_b16 v[50:51], v249 offset:18432
    ds_read_b64_tr_b16 v[52:53], v248 offset:16384
    ds_read_b64_tr_b16 v[54:55], v250 offset:18432
    ds_read_b64_tr_b16 v[56:57], v248 offset:21504
    ds_read_b64_tr_b16 v[58:59], v249 offset:25600
    ds_read_b64_tr_b16 v[60:61], v248 offset:23552
    ds_read_b64_tr_b16 v[62:63], v250 offset:25600
    ds_read_b64_tr_b16 v[64:65], v248 offset:28672
    ds_read_b64_tr_b16 v[66:67], v249 offset:32768
    ds_read_b64_tr_b16 v[68:69], v248 offset:30720
    ds_read_b64_tr_b16 v[70:71], v250 offset:32768
    ds_read_b64_tr_b16 v[72:73], v248 offset:35840
    ds_read_b64_tr_b16 v[74:75], v249 offset:39936
    ds_read_b64_tr_b16 v[76:77], v248 offset:37888
    ds_read_b64_tr_b16 v[78:79], v250 offset:39936
    ds_read_b64_tr_b16 v[80:81], v248 offset:43008
    ds_read_b64_tr_b16 v[82:83], v249 offset:47104
    ds_read_b64_tr_b16 v[84:85], v248 offset:45056
    ds_read_b64_tr_b16 v[86:87], v250 offset:47104
    ds_read_b64_tr_b16 v[88:89], v248 offset:50176
    ds_read_b64_tr_b16 v[90:91], v249 offset:54272
    ds_read_b64_tr_b16 v[92:93], v248 offset:52224
    ds_read_b64_tr_b16 v[94:95], v250 offset:54272
    ds_read_b64_tr_b16 v[96:97], v251 offset:0
    ds_read_b64_tr_b16 v[98:99], v252 offset:4096
    ds_read_b64_tr_b16 v[100:101], v251 offset:2048
    ds_read_b64_tr_b16 v[102:103], v253 offset:4096
    ds_read_b64_tr_b16 v[104:105], v251 offset:7168
    ds_read_b64_tr_b16 v[106:107], v252 offset:11264
    ds_read_b64_tr_b16 v[108:109], v251 offset:9216
    ds_read_b64_tr_b16 v[110:111], v253 offset:11264
    ds_read_b64_tr_b16 v[112:113], v251 offset:14336
    ds_read_b64_tr_b16 v[114:115], v252 offset:18432
    ds_read_b64_tr_b16 v[116:117], v251 offset:16384
    ds_read_b64_tr_b16 v[118:119], v253 offset:18432
    ds_read_b64_tr_b16 v[120:121], v251 offset:21504
    ds_read_b64_tr_b16 v[122:123], v252 offset:25600
    ds_read_b64_tr_b16 v[124:125], v251 offset:23552
    ds_read_b64_tr_b16 v[126:127], v253 offset:25600
    ds_read_b64_tr_b16 v[128:129], v251 offset:28672
    ds_read_b64_tr_b16 v[130:131], v252 offset:32768
    ds_read_b64_tr_b16 v[132:133], v251 offset:30720
    ds_read_b64_tr_b16 v[134:135], v253 offset:32768
    ds_read_b64_tr_b16 v[136:137], v251 offset:35840
    ds_read_b64_tr_b16 v[138:139], v252 offset:39936
    ds_read_b64_tr_b16 v[140:141], v251 offset:37888
    ds_read_b64_tr_b16 v[142:143], v253 offset:39936
    ds_read_b64_tr_b16 v[144:145], v251 offset:43008
    ds_read_b64_tr_b16 v[146:147], v252 offset:47104
    ds_read_b64_tr_b16 v[148:149], v251 offset:45056
    ds_read_b64_tr_b16 v[150:151], v253 offset:47104
    ds_read_b64_tr_b16 v[152:153], v251 offset:50176
    ds_read_b64_tr_b16 v[154:155], v252 offset:54272
    ds_read_b64_tr_b16 v[156:157], v251 offset:52224
    ds_read_b64_tr_b16 v[158:159], v253 offset:54272
    ds_add_u32 v4, v6 offset:3072
    s_cmp_ge_u32 s4, 7
    s_cbranch_scc1 co_ny107
    buffer_load_dwordx2 v[10:11], v18, s[48:51], s18 offen sc1
    ds_read_b32 v7, v4 offset:3584
    s_waitcnt lgkmcnt(0)
    v_readfirstlane_b32 s47, v7
    s_nop 0
    s_cmp_lt_u32 s47, 4
    s_cbranch_scc1 co_sp108
co_ok109:
    s_waitcnt vmcnt(0)
    v_cmp_ne_u64 vcc, v[10:11], v[8:9]
    s_nop 0
    s_cbranch_vccnz co_sq110
co_ok112:
    s_mov_b32 m0, s21
    s_nop 0
    buffer_load_dwordx4 v244, s[48:51], s19 offen sc1 lds
    s_add_u32 m0, s21, 1024
    s_nop 0
    buffer_load_dwordx4 v244, s[48:51], s20 offen sc1 lds
    s_waitcnt vmcnt(0)
    ds_read_b64_tr_b16 v[24:25], v245 offset:0
    ds_read_b64_tr_b16 v[26:27], v245 offset:128
    ds_read_b64_tr_b16 v[28:29], v245 offset:16
    ds_read_b64_tr_b16 v[30:31], v245 offset:144
    s_waitcnt lgkmcnt(2)
    buffer_store_dwordx4 v[24:27], v246, s[56:59], s22 offen sc1
    s_waitcnt lgkmcnt(0)
    buffer_store_dwordx4 v[28:31], v246, s[56:59], s23 offen sc1
co_ny107:
    ds_add_u32 v4, v6 offset:3584
    s_mul_i32 s68, s3, 56
    s_add_u32 s68, s68, 8192
    s_and_b32 s64, s5, 3
    s_mul_i32 s64, s64, 224
    s_lshl_b32 s69, s4, 3
    s_lshr_b32 s70, s5, 2
    s_add_u32 s69, s69, s70
    s_lshl_b32 s26, s69, 15
    s_lshl_b32 s70, s3, 13
    s_add_u32 s26, s26, s70
    s_add_u32 s26, s26, 6291456
    s_add_u32 s27, s26, 4096
    s_add_u32 s70, s70, 122880
    v_add_u32 v13, 122880, v5
    v_add_u32 v12, s70, v5
    v_and_b32 v20, 3, v1
    v_mul_u32_u24 v20, 0x6ef372, v20
    v_add_u32 v20, 0x9e3779b1, v20
    v_xor_b32 v2, v8, v9
    v_mul_lo_u32 v20, v20, v2
    v_lshrrev_b32 v20, 19, v20
    v_or_b32 v20, 0x4000, v20
    v_lshl_or_b32 v20, v20, 16, v20
    s_mov_b32 s29, 0x07060302
    s_lshl_b32 s70, s69, 2
    s_add_u32 s70, s70, s3
    s_lshl_b32 s70, s70, 11
    s_add_u32 s70, s70, 14745600
    v_and_b32 v2, 3, v1
    v_lshl_add_u32 v21, v2, 9, s70
    v_and_b32 v2, 31, v1
    v_mul_u32_u24 v2, 240, v2
    v_lshrrev_b32 v3, 5, v1
    v_lshl_add_u32 v2, v3, 3, v2
    v_add_u32 v14, s68, v2
    v_add_u32 v2, -256, v0
    v_mul_u32_u24 v3, 4682, v2
    v_lshrrev_b32 v3, 16, v3
    v_mul_u32_u24 v17, 14, v3
    v_sub_u32 v2, v2, v17
    v_lshlrev_b32 v2, 4, v2
    v_mul_u32_u24 v15, 240, v3
    v_add_u32 v15, v15, v2
    v_mul_u32_u24 v17, 1792, v3
    v_add_u32 v17, v17, v2
    v_add_u32 v2, 0, v0
    v_mul_u32_u24 v3, 4682, v2
    v_lshrrev_b32 v3, 16, v3
    v_mul_u32_u24 v19, 14, v3
    v_sub_u32 v2, v2, v19
    v_lshlrev_b32 v2, 4, v2
    v_mul_u32_u24 v16, 240, v3
    v_add_u32 v16, v16, v2
    v_mul_u32_u24 v19, 1792, v3
    v_add_u32 v19, v19, v2
    s_mul_i32 s28, s69, 57344
    s_add_u32 s28, s28, s64
    s_add_u32 s28, s28, 896
    ds_read_b32 v7, v4 offset:3584
    s_waitcnt lgkmcnt(0)
    v_readfirstlane_b32 s47, v7
    s_nop 0
    s_cmp_lt_u32 s47, 8
    s_cbranch_scc1 co_sp113
co_ok114:
    v_mov_b32 v10, 0
    v_mov_b32 v11, 0
    s_mov_b64 exec, 15
    buffer_atomic_or_x2 v[10:11], v21, s[48:51], 0 offen sc0 sc1
    s_mov_b64 exec, -1
    v_and_b32 v35, 0xffff, v35
    v_and_b32 v39, 0xffff, v39
    v_and_b32 v43, 0xffff, v43
    v_and_b32 v47, 0xffff, v47
    v_and_b32 v51, 0xffff, v51
    v_and_b32 v55, 0xffff, v55
    v_and_b32 v59, 0xffff, v59
    v_and_b32 v63, 0xffff, v63
    v_and_b32 v67, 0xffff, v67
    v_and_b32 v71, 0xffff, v71
    v_and_b32 v75, 0xffff, v75
    v_and_b32 v79, 0xffff, v79
    v_and_b32 v83, 0xffff, v83
    v_and_b32 v87, 0xffff, v87
    v_and_b32 v91, 0xffff, v91
    v_and_b32 v95, 0xffff, v95
    v_and_b32 v99, 0xffff, v99
    v_and_b32 v103, 0xffff, v103
    v_and_b32 v107, 0xffff, v107
    v_and_b32 v111, 0xffff, v111
    v_and_b32 v115, 0xffff, v115
    v_and_b32 v119, 0xffff, v119
    v_and_b32 v123, 0xffff, v123
    v_and_b32 v127, 0xffff, v127
    v_and_b32 v131, 0xffff, v131
    v_and_b32 v135, 0xffff, v135
    v_and_b32 v139, 0xffff, v139
    v_and_b32 v143, 0xffff, v143
    v_and_b32 v147, 0xffff, v147
    v_and_b32 v151, 0xffff, v151
    v_and_b32 v155, 0xffff, v155
    v_and_b32 v159, 0xffff, v159
    s_mov_b32 s14, 15
    s_mov_b32 s15, 0
    s_branch co_rd117
co_rd116:
    s_waitcnt vmcnt(0)
co_rd118:
    s_bitcmp0_b32 s15, 0
    s_cbranch_scc1 co_nx119
    ds_write_b128 v12, v[160:163] offset:0
    ds_write_b128 v12, v[164:167] offset:1024
    v_perm_b32 v192, v167, v163, s29
    v_cmp_ne_u32 vcc, v192, v20
    s_nop 0
    s_cbranch_vccnz co_nx119
    s_bitset0_b32 s14, 0
co_nx119:
    s_bitcmp0_b32 s15, 1
    s_cbranch_scc1 co_nx120
    ds_write_b128 v12, v[168:171] offset:2048
    ds_write_b128 v12, v[172:175] offset:3072
    v_perm_b32 v193, v175, v171, s29
    v_cmp_ne_u32 vcc, v193, v20
    s_nop 0
    s_cbranch_vccnz co_nx120
    s_bitset0_b32 s14, 1
co_nx120:
    s_bitcmp0_b32 s15, 2
    s_cbranch_scc1 co_nx121
    ds_write_b128 v12, v[176:179] offset:4096
    ds_write_b128 v12, v[180:183] offset:5120
    v_perm_b32 v194, v183, v179, s29
    v_cmp_ne_u32 vcc, v194, v20
    s_nop 0
    s_cbranch_vccnz co_nx121
    s_bitset0_b32 s14, 2
co_nx121:
    s_bitcmp0_b32 s15, 3
    s_cbranch_scc1 co_nx122
    ds_write_b128 v12, v[184:187] offset:6144
    ds_write_b128 v12, v[188:191] offset:7168
    v_perm_b32 v195, v191, v187, s29
    v_cmp_ne_u32 vcc, v195, v20
    s_nop 0
    s_cbranch_vccnz co_nx122
    s_bitset0_b32 s14, 3
co_nx122:
    s_cmp_eq_u32 s14, 0
    s_cbranch_scc1 co_ok115
    s_add_u32 s46, s46, 1
    s_cmp_gt_u32 s46, 262144
    s_cbranch_scc1 co_ok115
    s_waitcnt lgkmcnt(0)
co_rd117:
    s_waitcnt vmcnt(0)
    v_cmp_eq_u64 vcc, v[10:11], v[8:9]
    s_andn2_b32 s15, s14, s15
    s_and_b32 s15, vcc_lo, s15
    s_bitcmp0_b32 s15, 0
    s_cbranch_scc1 co_nx123
    buffer_load_dwordx4 v[160:163], v5, s[48:51], s26 offen offset:0 sc1
    buffer_load_dwordx4 v[164:167], v5, s[48:51], s26 offen offset:1024 sc1
co_nx123:
    s_bitcmp0_b32 s15, 1
    s_cbranch_scc1 co_nx124
    buffer_load_dwordx4 v[168:171], v5, s[48:51], s26 offen offset:2048 sc1
    buffer_load_dwordx4 v[172:175], v5, s[48:51], s26 offen offset:3072 sc1
co_nx124:
    s_bitcmp0_b32 s15, 2
    s_cbranch_scc1 co_nx125
    buffer_load_dwordx4 v[176:179], v5, s[48:51], s27 offen offset:0 sc1
    buffer_load_dwordx4 v[180:183], v5, s[48:51], s27 offen offset:1024 sc1
co_nx125:
    s_bitcmp0_b32 s15, 3
    s_cbranch_scc1 co_nx126
    buffer_load_dwordx4 v[184:187], v5, s[48:51], s27 offen offset:2048 sc1
    buffer_load_dwordx4 v[188:191], v5, s[48:51], s27 offen offset:3072 sc1
co_nx126:
    s_cmp_eq_u32 s14, s15
    s_cbranch_scc1 co_rd116
    v_mov_b32 v10, 0
    v_mov_b32 v11, 0
    s_mov_b64 exec, 15
    buffer_atomic_or_x2 v[10:11], v21, s[48:51], 0 offen sc0 sc1
    s_mov_b64 exec, -1
    s_branch co_rd116
co_ok115:
    s_waitcnt vmcnt(0) lgkmcnt(0)
    s_barrier
    ds_read_b128 v[160:163], v13 offset:0
    ds_read_b128 v[164:167], v13 offset:1024
    ds_read_b128 v[168:171], v13 offset:2048
    ds_read_b128 v[172:175], v13 offset:3072
    ds_read_b128 v[176:179], v13 offset:4096
    ds_read_b128 v[180:183], v13 offset:5120
    ds_read_b128 v[184:187], v13 offset:6144
    ds_read_b128 v[188:191], v13 offset:7168
    s_waitcnt lgkmcnt(7)
    v_mfma_f32_32x32x16_bf16 v[192:207], v[32:35], v[160:163], 0
    ds_read_b128 v[160:163], v13 offset:8192
    s_waitcnt lgkmcnt(7)
    v_mfma_f32_32x32x16_bf16 v[192:207], v[36:39], v[164:167], v[192:207]
    ds_read_b128 v[164:167], v13 offset:9216
    s_waitcnt lgkmcnt(7)
    v_mfma_f32_32x32x16_bf16 v[192:207], v[40:43], v[168:171], v[192:207]
    ds_read_b128 v[168:171], v13 offset:10240
    s_waitcnt lgkmcnt(7)
    v_mfma_f32_32x32x16_bf16 v[192:207], v[44:47], v[172:175], v[192:207]
    ds_read_b128 v[172:175], v13 offset:11264
    s_waitcnt lgkmcnt(7)
    v_mfma_f32_32x32x16_bf16 v[192:207], v[48:51], v[176:179], v[192:207]
    ds_read_b128 v[176:179], v13 offset:12288
    s_waitcnt lgkmcnt(7)
    v_mfma_f32_32x32x16_bf16 v[192:207], v[52:55], v[180:183], v[192:207]
    ds_read_b128 v[180:183], v13 offset:13312
    s_waitcnt lgkmcnt(7)
    v_mfma_f32_32x32x16_bf16 v[192:207], v[56:59], v[184:187], v[192:207]
    ds_read_b128 v[184:187], v13 offset:14336
    s_waitcnt lgkmcnt(7)
    v_mfma_f32_32x32x16_bf16 v[192:207], v[60:63], v[188:191], v[192:207]
    ds_read_b128 v[188:191], v13 offset:15360
    s_waitcnt lgkmcnt(7)
    v_mfma_f32_32x32x16_bf16 v[192:207], v[64:67], v[160:163], v[192:207]
    ds_read_b128 v[160:163], v13 offset:16384
    s_waitcnt lgkmcnt(7)
    v_mfma_f32_32x32x16_bf16 v[192:207], v[68:71], v[164:167], v[192:207]
    ds_read_b128 v[164:167], v13 offset:17408
    s_waitcnt lgkmcnt(7)
    v_mfma_f32_32x32x16_bf16 v[192:207], v[72:75], v[168:171], v[192:207]
    ds_read_b128 v[168:171], v13 offset:18432
    s_waitcnt lgkmcnt(7)
    v_mfma_f32_32x32x16_bf16 v[192:207], v[76:79], v[172:175], v[192:207]
    ds_read_b128 v[172:175], v13 offset:19456
    s_waitcnt lgkmcnt(7)
    v_mfma_f32_32x32x16_bf16 v[192:207], v[80:83], v[176:179], v[192:207]
    ds_read_b128 v[176:179], v13 offset:20480
    s_waitcnt lgkmcnt(7)
    v_mfma_f32_32x32x16_bf16 v[192:207], v[84:87], v[180:183], v[192:207]
    ds_read_b128 v[180:183], v13 offset:21504
    s_waitcnt lgkmcnt(7)
    v_mfma_f32_32x32x16_bf16 v[192:207], v[88:91], v[184:187], v[192:207]
    ds_read_b128 v[184:187], v13 offset:22528
    s_waitcnt lgkmcnt(7)
    v_mfma_f32_32x32x16_bf16 v[192:207], v[92:95], v[188:191], v[192:207]
    ds_read_b128 v[188:191], v13 offset:23552
    s_waitcnt lgkmcnt(7)
    v_mfma_f32_32x32x16_bf16 v[192:207], v[96:99], v[160:163], v[192:207]
    ds_read_b128 v[160:163], v13 offset:24576
    s_waitcnt lgkmcnt(7)
    v_mfma_f32_32x32x16_bf16 v[192:207], v[100:103], v[164:167], v[192:207]
    ds_read_b128 v[164:167], v13 offset:25600
    s_waitcnt lgkmcnt(7)
    v_mfma_f32_32x32x16_bf16 v[192:207], v[104:107], v[168:171], v[192:207]
    ds_read_b128 v[168:171], v13 offset:26624
    s_waitcnt lgkmcnt(7)
    v_mfma_f32_32x32x16_bf16 v[192:207], v[108:111], v[172:175], v[192:207]
    ds_read_b128 v[172:175], v13 offset:27648
    s_waitcnt lgkmcnt(7)
    v_mfma_f32_32x32x16_bf16 v[192:207], v[112:115], v[176:179], v[192:207]
    ds_read_b128 v[176:179], v13 offset:28672
    s_waitcnt lgkmcnt(7)
    v_mfma_f32_32x32x16_bf16 v[192:207], v[116:119], v[180:183], v[192:207]
    ds_read_b128 v[180:183], v13 offset:29696
    s_waitcnt lgkmcnt(7)
    v_mfma_f32_32x32x16_bf16 v[192:207], v[120:123], v[184:187], v[192:207]
    ds_read_b128 v[184:187], v13 offset:30720
    s_waitcnt lgkmcnt(7)
    v_mfma_f32_32x32x16_bf16 v[192:207], v[124:127], v[188:191], v[192:207]
    ds_read_b128 v[188:191], v13 offset:31744
    s_waitcnt lgkmcnt(7)
    v_mfma_f32_32x32x16_bf16 v[192:207], v[128:131], v[160:163], v[192:207]
    s_waitcnt lgkmcnt(6)
    v_mfma_f32_32x32x16_bf16 v[192:207], v[132:135], v[164:167], v[192:207]
    s_waitcnt lgkmcnt(5)
    v_mfma_f32_32x32x16_bf16 v[192:207], v[136:139], v[168:171], v[192:207]
    s_waitcnt lgkmcnt(4)
    v_mfma_f32_32x32x16_bf16 v[192:207], v[140:143], v[172:175], v[192:207]
    s_waitcnt lgkmcnt(3)
    v_mfma_f32_32x32x16_bf16 v[192:207], v[144:147], v[176:179], v[192:207]
    s_waitcnt lgkmcnt(2)
    v_mfma_f32_32x32x16_bf16 v[192:207], v[148:151], v[180:183], v[192:207]
    s_waitcnt lgkmcnt(1)
    v_mfma_f32_32x32x16_bf16 v[192:207], v[152:155], v[184:187], v[192:207]
    s_waitcnt lgkmcnt(0)
    v_mfma_f32_32x32x16_bf16 v[192:207], v[156:159], v[188:191], v[192:207]
    s_nop 11
    v_cvt_pk_bf16_f32 v24, v192, v193
    v_cvt_pk_bf16_f32 v25, v194, v195
    v_cvt_pk_bf16_f32 v26, v196, v197
    v_cvt_pk_bf16_f32 v27, v198, v199
    v_cvt_pk_bf16_f32 v28, v200, v201
    v_cvt_pk_bf16_f32 v29, v202, v203
    v_cvt_pk_bf16_f32 v30, v204, v205
    v_cvt_pk_bf16_f32 v31, v206, v207
    ds_write_b64 v14, v[24:25] offset:0
    ds_write_b64 v14, v[26:27] offset:16
    ds_write_b64 v14, v[28:29] offset:32
    s_mov_b64 exec, 0xffffffff
    ds_write_b64 v14, v[30:31] offset:48
    s_mov_b64 exec, -1
    s_waitcnt lgkmcnt(0)
    s_barrier
    ds_read_b128 v[160:163], v15 offset:8192
    s_cmp_eq_u32 s3, 3
    s_cbranch_scc1 L_A6
    ds_read_b128 v[164:167], v16 offset:8192
    s_waitcnt lgkmcnt(0)
    buffer_store_dwordx4 v[164:167], v19, s[56:59], s28 offen
L_A6:
    s_waitcnt lgkmcnt(0)
    buffer_store_dwordx4 v[160:163], v17, s[56:59], s28 offen
    s_endpgm
co_sp83:
    buffer_load_dwordx2 v[8:9], off, s[60:63], 0 sc1
    s_waitcnt vmcnt(0)
    s_add_u32 s46, s46, 1
    s_cmp_gt_u32 s46, 262144
    s_cbranch_scc1 co_ok84
    v_cmp_eq_u32 vcc, 0, v8
    s_nop 0
    s_cbranch_vccnz co_sp83
    s_branch co_ok84
co_sq85:
    s_mov_b32 s47, 32756
co_sp86:
    buffer_load_dwordx2 v[10:11], v18, s[48:51], s69 offen sc1
    s_add_u32 s47, s47, 1
    s_and_b32 vcc_lo, s47, 0x8000
    s_or_b32 s69, s69, vcc_lo
    s_waitcnt vmcnt(0)
    s_add_u32 s46, s46, 1
    s_cmp_gt_u32 s46, 262144
    s_cbranch_scc1 co_ok87
    v_cmp_ne_u64 vcc, v[10:11], v[8:9]
    s_nop 0
    s_cbranch_vccnz co_sp86
    s_branch co_ok87
co_sp88:
    ds_read_b32 v7, v236 offset:2304
    s_add_u32 s46, s46, 1
    s_cmp_gt_u32 s46, 262144
    s_cbranch_scc1 co_ok89
    s_waitcnt lgkmcnt(0)
    v_readfirstlane_b32 s47, v7
    s_nop 0
    s_cmp_lt_u32 s47, 2
    s_cbranch_scc1 co_sp88
    s_branch co_ok89
co_sp90:
    ds_read_b32 v7, v4 offset:3840
    s_add_u32 s46, s46, 1
    s_cmp_gt_u32 s46, 262144
    s_cbranch_scc1 co_ok91
    s_waitcnt lgkmcnt(0)
    v_readfirstlane_b32 s47, v7
    s_nop 0
    s_cmp_lt_u32 s47, 4
    s_cbranch_scc1 co_sp90
    s_branch co_ok91
co_sp92:
    ds_read_b32 v7, v236 offset:2304
    s_add_u32 s46, s46, 1
    s_cmp_gt_u32 s46, 262144
    s_cbranch_scc1 co_ok93
    s_waitcnt lgkmcnt(0)
    v_readfirstlane_b32 s47, v7
    s_nop 0
    s_cmp_lt_u32 s47, 4
    s_cbranch_scc1 co_sp92
    s_branch co_ok93
co_sp94:
    ds_read_b32 v7, v4 offset:2048
    s_add_u32 s46, s46, 1
    s_cmp_gt_u32 s46, 262144
    s_cbranch_scc1 co_ok95
    s_waitcnt lgkmcnt(0)
    v_readfirstlane_b32 s47, v7
    s_nop 0
    s_cmp_lt_u32 s47, 8
    s_cbranch_scc1 co_sp94
    s_branch co_ok95
co_sp96:
    ds_read_b32 v7, v236 offset:2304
    s_add_u32 s46, s46, 1
    s_cmp_gt_u32 s46, 262144
    s_cbranch_scc1 co_ok97
    s_waitcnt lgkmcnt(0)
    v_readfirstlane_b32 s47, v7
    s_nop 0
    s_cmp_lt_u32 s47, 6
    s_cbranch_scc1 co_sp96
    s_branch co_ok97
co_sp98:
    ds_read_b32 v7, v236 offset:2304
    s_add_u32 s46, s46, 1
    s_cmp_gt_u32 s46, 262144
    s_cbranch_scc1 co_ok99
    s_waitcnt lgkmcnt(0)
    v_readfirstlane_b32 s47, v7
    s_nop 0
    s_cmp_lt_u32 s47, 6
    s_cbranch_scc1 co_sp98
    s_branch co_ok99
co_sp101:
    ds_read_b32 v7, v4 offset:2048
    s_add_u32 s46, s46, 1
    s_cmp_gt_u32 s46, 262144
    s_cbranch_scc1 co_ok102
    s_waitcnt lgkmcnt(0)
    v_readfirstlane_b32 s47, v7
    s_nop 0
    s_cmp_lt_u32 s47, 8
    s_cbranch_scc1 co_sp101
    s_branch co_ok102
co_sp103:
    buffer_load_dwordx2 v[8:9], off, s[60:63], 0 sc1
    s_waitcnt vmcnt(0)
    s_add_u32 s46, s46, 1
    s_cmp_gt_u32 s46, 262144
    s_cbranch_scc1 co_ok104
    v_cmp_eq_u32 vcc, 0, v8
    s_nop 0
    s_cbranch_vccnz co_sp103
    s_branch co_ok104
co_sp105:
    ds_read_b32 v7, v4 offset:2816
    s_add_u32 s46, s46, 1
    s_cmp_gt_u32 s46, 262144
    s_cbranch_scc1 co_ok106
    s_waitcnt lgkmcnt(0)
    v_readfirstlane_b32 s47, v7
    s_nop 0
    s_cmp_lt_u32 s47, 4
    s_cbranch_scc1 co_sp105
    s_branch co_ok106
co_sp108:
    ds_read_b32 v7, v4 offset:3584
    s_add_u32 s46, s46, 1
    s_cmp_gt_u32 s46, 262144
    s_cbranch_scc1 co_ok109
    s_waitcnt lgkmcnt(0)
    v_readfirstlane_b32 s47, v7
    s_nop 0
    s_cmp_lt_u32 s47, 4
    s_cbranch_scc1 co_sp108
    s_branch co_ok109
co_sq110:
    s_mov_b32 s47, 32756
co_sp111:
    buffer_load_dwordx2 v[10:11], v18, s[48:51], s18 offen sc1
    s_add_u32 s47, s47, 1
    s_and_b32 vcc_lo, s47, 0x8000
    s_or_b32 s18, s18, vcc_lo
    s_waitcnt vmcnt(0)
    s_add_u32 s46, s46, 1
    s_cmp_gt_u32 s46, 262144
    s_cbranch_scc1 co_ok112
    v_cmp_ne_u64 vcc, v[10:11], v[8:9]
    s_nop 0
    s_cbranch_vccnz co_sp111
    s_branch co_ok112
co_sp113:
    ds_read_b32 v7, v4 offset:3584
    s_add_u32 s46, s46, 1
    s_cmp_gt_u32 s46, 262144
    s_cbranch_scc1 co_ok114
    s_waitcnt lgkmcnt(0)
    v_readfirstlane_b32 s47, v7
    s_nop 0
    s_cmp_lt_u32 s47, 8
    s_cbranch_scc1 co_sp113
    s_branch co_ok114
L_end:
    s_endpgm
.section .rodata,"a"
.p2align 6
.amdhsa_kernel concat_heads__ssm_conv_s4__softmax_full_mha__prompt_kernel
  .amdhsa_next_free_vgpr 256
  .amdhsa_next_free_sgpr 76
  .amdhsa_accum_offset 256
  .amdhsa_group_segment_fixed_size 0
  .amdhsa_kernarg_size 120
  .amdhsa_user_sgpr_count 2
  .amdhsa_user_sgpr_kernarg_segment_ptr 1
  .amdhsa_system_sgpr_workgroup_id_x 1
.end_amdhsa_kernel
```
